```python
import torch

def _softmax(x, axis=-1):
    return torch.softmax(x, dim=axis)

def _gelu(x):
    return torch.nn.functional.gelu(x, approximate='tanh')

def _silu(x):
    return torch.nn.functional.silu(x)

def _sigmoid(x):
    return torch.sigmoid(x)

def _layernorm(x, axis=-1, eps=1e-05):
    m = x.mean(dim=axis, keepdim=True)
    v = x.var(dim=axis, keepdim=True, unbiased=False)
    return (x - m) / torch.sqrt(v + eps)

def _scatter_add(tgt, idx, src, axis=0):
    return tgt.clone().index_add_(axis, idx, src)

def _segment_sum(src, seg, n):
    out = torch.zeros((n,) + src.shape[1:], dtype=src.dtype)
    return out.index_add_(0, seg, src)

def _pad(x, pw):
    flat = tuple((v for pair in reversed(pw) for v in pair))
    return torch.nn.functional.pad(x, flat)
kernel_name = 'adaLN_cond__mha_block_cached__glu_gated_swiglu__decode'

def setup_inputs():

    _w = lambda a: (lambda t: t.to(torch.bfloat16) if t.is_floating_point() else t)(torch.as_tensor(a))

    def _A_setup():
        B, Sq, D = (1, 1, 512)
        H, Sk, Dh = (32, 4096, 128)
        return {'x': _w((lambda *s: torch.randn(*s, dtype=torch.bfloat16) * 0.05)(B, Sq, D)), 'k_cache': _w((lambda *s: torch.randn(*s, dtype=torch.bfloat16) * 3.2)(B, H, Sk, Dh)), 'v_cache': _w((lambda *s: torch.randn(*s, dtype=torch.bfloat16) * 3.2)(B, H, Sk, Dh)), 'wq': _w((lambda *s: torch.randn(*s, dtype=torch.bfloat16) * 3.2)(D, H * Dh) * D ** (-0.5)), 'wo': _w((lambda *s: torch.randn(*s, dtype=torch.bfloat16) * 3.2)(H * Dh, D) * (H * Dh) ** (-0.5))}
    _A_in = _A_setup()

    def _B_setup():
        B, S, D, F = (1, 1, 512, 1376)
        return {'x': _w((lambda *s: torch.randn(*s, dtype=torch.bfloat16) * 0.05)(B, S, D)), 'w1': _w((lambda *s: torch.randn(*s, dtype=torch.bfloat16) * 1.6)(D, F) * (2.0 / D) ** 0.5), 'w3': _w((lambda *s: torch.randn(*s, dtype=torch.bfloat16) * 1.6)(D, F) * (2.0 / D) ** 0.5), 'w2': _w((lambda *s: torch.randn(*s, dtype=torch.bfloat16) * 1.6)(F, D) * (2.0 / F) ** 0.5)}
    _B_in = _B_setup()
    return {'A_x': _A_in['x'], 'A_k_cache': _A_in['k_cache'], 'A_v_cache': _A_in['v_cache'], 'A_wq': _A_in['wq'], 'A_wo': _A_in['wo'], 'B_x': _B_in['x'], 'B_w1': _B_in['w1'], 'B_w3': _B_in['w3'], 'B_w2': _B_in['w2'], 'c': _w((lambda *s: torch.randn(*s, dtype=torch.bfloat16) * 0.2)(1, 512) * 8.0), 'w_mod': _w((lambda *s: torch.randn(*s, dtype=torch.bfloat16) * 0.2)(512, 6 * 512) * 512 ** (-0.5) * 8.0)}

def reference(A_x, A_k_cache, A_v_cache, A_wq, A_wo, B_x, B_w1, B_w3, B_w2, c, w_mod):

    def _A_ref(x, k_cache, v_cache, wq, wo):
        B, Sq, D = x.shape
        H, Dh = (32, 128)
        q = (lambda x, *d: x.permute(*d))((x @ wq).reshape(B, Sq, H, Dh), 0, 2, 1, 3)
        scores = torch.einsum('bhqd,bhkd->bhqk', q, k_cache) * Dh ** (-0.5)
        p = _softmax(scores, axis=-1)
        o = torch.einsum('bhqk,bhkd->bhqd', p, v_cache)
        return (lambda x, *d: x.permute(*d))(o, 0, 2, 1, 3).reshape(B, Sq, H * Dh) @ wo

    def _B_ref(x, w1, w3, w2):
        gate = torch.einsum('bsd,df->bsf', x, w1)
        up = torch.einsum('bsd,df->bsf', x, w3)
        h = _silu(gate) * up
        out = torch.einsum('bsf,fd->bsd', h, w2)
        return out
    x = A_x
    mod = (_silu(c) @ w_mod).reshape(c.shape[0], 6, 1, -1)
    sa, ca, ga, sb, cb, gb = (mod[:, 0].clone(), mod[:, 1].clone(), mod[:, 2].clone(), mod[:, 3].clone(), mod[:, 4].clone(), mod[:, 5].clone())
    h = _layernorm(x, axis=-1) * (1 + ca) + sa
    x = x + ga * _A_ref(h, A_k_cache, A_v_cache, A_wq, A_wo)
    h = _layernorm(x, axis=-1) * (1 + cb) + sb
    x = x + gb * _B_ref(h, B_w1, B_w3, B_w2)
    return x
```

```asm
; @launch grid=(256,1,1) block=(512,1,1) lds=135680
.amdgcn_target "amdgcn-amd-amdhsa--gfx950"
.text
.globl adaLN_cond__mha_block_cached__glu_gated_swiglu__decode_kernel
.p2align 12
.p2align 8
.type adaLN_cond__mha_block_cached__glu_gated_swiglu__decode_kernel,@function
adaLN_cond__mha_block_cached__glu_gated_swiglu__decode_kernel:
    s_cmp_ge_u32 s2, 256
    s_cbranch_scc1 L_END
    s_load_dwordx4 s[4:7], s[0:1], 8
    s_load_dwordx16 s[48:63], s[0:1], 24
    s_load_dwordx2 s[40:41], s[0:1], 104
    s_load_dwordx2 s[64:65], s[0:1], 0
    s_load_dwordx2 s[66:67], s[0:1], 88
    v_lshrrev_b32 v1, 6, v0
    v_and_b32 v0, 63, v0
    v_readfirstlane_b32 s3, v1
    v_lshlrev_b32 v1, 2, v0
    v_add_u32 v1, 0x21100, v1
    v_mov_b32 v2, 0
    ds_write_b32 v1, v2
    s_and_b32 s36, s2, 31
    s_lshr_b32 s37, s2, 5
    s_and_b32 s38, s2, 7
    s_lshr_b32 s39, s2, 3
    s_cmp_ge_u32 s3, 4
    s_cbranch_scc1 L_CPRE
    v_lshrrev_b32 v1, 4, v0
    v_and_b32 v2, 15, v0
    v_lshlrev_b32 v12, 4, v0
    v_lshlrev_b32 v3, 2, v1
    v_xor_b32 v2, v2, v3
    v_lshlrev_b32 v2, 4, v2
    v_lshl_add_u32 v8, v1, 8, v2
    v_xor_b32 v9, 16, v8
    v_xor_b32 v10, 32, v8
    v_xor_b32 v11, 48, v8
    s_lshl_b32 s69, s36, 20
    s_lshl_b32 s72, s37, 2
    s_add_u32 s72, s72, s3
    s_lshl_b32 s72, s72, 12
    s_mul_i32 s45, s36, 32768
    s_add_u32 s72, s72, s45
    s_and_b32 s72, s72, 0x1f000
    s_mul_i32 s78, s36, 0
    s_and_b32 s78, s78, 7
    s_lshl_b32 s78, s78, 17
    s_mov_b32 s76, s78
    s_mov_b32 s77, s72
    s_add_u32 s70, s76, s77
    s_lshr_b32 s70, s70, 2
    s_add_u32 s70, s70, s69
    s_lshl_b32 s45, s3, 15
    s_mov_b32 m0, s45
    s_mov_b32 s46, 0
    s_waitcnt lgkmcnt(0)
    s_mov_b32 s8, s4
    s_mov_b32 s9, s5
    s_mov_b32 s10, 0x2000000
    s_mov_b32 s11, 0x20000
L_KLOOP:
    s_waitcnt vmcnt(5)
    buffer_load_dwordx4 v8, s[8:11], s70 offen offset:0 nt lds
    s_add_u32 s70, s70, 261120
    s_waitcnt vmcnt(5)
    buffer_load_dwordx4 v9, s[8:11], s70 offen offset:1024 nt lds
    s_add_u32 s70, s70, 261120
    s_waitcnt vmcnt(5)
    buffer_load_dwordx4 v10, s[8:11], s70 offen offset:2048 nt lds
    s_add_u32 s70, s70, 261120
    s_waitcnt vmcnt(5)
    buffer_load_dwordx4 v11, s[8:11], s70 offen offset:3072 nt lds
    s_cmp_eq_u32 s46, 0
    s_cbranch_scc0 L_KL2
    s_barrier
L_KL2:
    s_add_u32 s76, s76, 0x20000
    s_and_b32 s76, s76, 0xe0000
    s_add_u32 s77, s77, 32768
    s_and_b32 s77, s77, 126976
    s_add_u32 s70, s76, s77
    s_lshr_b32 s70, s70, 2
    s_add_u32 s70, s70, s69
    s_add_u32 s45, s45, 4096
    s_mov_b32 m0, s45
    s_add_u32 s46, s46, 1
    s_cmp_lt_u32 s46, 8
    s_cbranch_scc1 L_KLOOP
    s_branch L_VPART
L_CPRE:
    s_cmp_eq_u32 s3, 7
    s_cbranch_scc0 L_NOCP
    s_getpc_b64 s[20:21]
L_PCREF:
    s_sub_u32 s20, s20, L_PCREF-adaLN_cond__mha_block_cached__glu_gated_swiglu__decode_kernel
    s_subb_u32 s21, s21, 0
    s_lshl_b32 s45, s39, 3
    v_and_b32 v1, 7, v0
    v_add_u32 v1, s45, v1
    v_lshlrev_b32 v1, 7, v1
    v_min_u32 v1, L_CODE_END-adaLN_cond__mha_block_cached__glu_gated_swiglu__decode_kernel-4, v1
    global_load_dword v240, v1, s[20:21]
L_NOCP:
    v_lshlrev_b32 v16, 2, v0
    v_lshrrev_b32 v1, 3, v0
    v_mul_u32_u24 v17, 98304, v1
    v_and_b32 v2, 7, v0
    v_lshl_add_u32 v17, v2, 4, v17
    v_lshrrev_b32 v1, 4, v0
    v_lshlrev_b32 v1, 7, v1
    v_lshl_add_u32 v19, v2, 4, v1
    v_lshlrev_b32 v60, 4, v0
    v_bfe_u32 v1, v0, 4, 1
    v_lshrrev_b32 v3, 5, v0
    v_lshl_add_u32 v1, v1, 1, v3
    v_lshl_add_u32 v33, v2, 2, v1
    v_lshlrev_b32 v33, 2, v33
    v_lshlrev_b32 v62, 14, v1
    v_and_b32 v2, 15, v0
    v_lshl_add_u32 v62, v2, 4, v62
    s_sub_u32 s47, s39, 16
    s_mov_b32 s35, s38
    s_and_b32 s45, s47, 1
    s_lshl_b32 s45, s45, 10
    s_lshl_b32 s46, s35, 7
    s_add_u32 s46, s46, s45
    s_lshr_b32 s45, s47, 1
    s_lshl_b32 s71, s37, 7
    s_waitcnt lgkmcnt(0)
    s_cmp_eq_u32 s3, 4
    s_cbranch_scc0 L_B0
    s_setprio 3
    s_cmp_lt_u32 s47, 8
    s_cbranch_scc0 L_XLD
    s_mov_b32 s20, s60
    s_mov_b32 s21, s61
    s_mov_b32 s22, 0x400
    s_mov_b32 s23, 0x20000
    s_mov_b32 s24, s62
    s_mov_b32 s25, s63
    s_mov_b32 s26, 0x300000
    s_mov_b32 s27, 0x20000
    s_lshl_b32 s70, s45, 8
    buffer_load_dword v18, v16, s[20:23], s70 offen
    s_mul_i32 s70, s45, 786432
    s_add_u32 s70, s70, s46
    buffer_load_dwordx4 v[64:67], v17, s[24:27], s70 offen nt
    s_add_u32 s70, s70, 6144
    buffer_load_dwordx4 v[68:71], v17, s[24:27], s70 offen nt
    s_add_u32 s70, s70, 6144
    buffer_load_dwordx4 v[72:75], v17, s[24:27], s70 offen nt
    s_add_u32 s70, s70, 6144
    buffer_load_dwordx4 v[76:79], v17, s[24:27], s70 offen nt
    s_add_u32 s70, s70, 6144
    buffer_load_dwordx4 v[80:83], v17, s[24:27], s70 offen nt
    s_add_u32 s70, s70, 6144
    buffer_load_dwordx4 v[84:87], v17, s[24:27], s70 offen nt
    s_add_u32 s70, s70, 6144
    buffer_load_dwordx4 v[88:91], v17, s[24:27], s70 offen nt
    s_add_u32 s70, s70, 6144
    buffer_load_dwordx4 v[92:95], v17, s[24:27], s70 offen nt
    s_add_u32 s70, s70, 6144
    buffer_load_dwordx4 v[96:99], v17, s[24:27], s70 offen nt
    s_add_u32 s70, s70, 6144
    buffer_load_dwordx4 v[100:103], v17, s[24:27], s70 offen nt
    s_add_u32 s70, s70, 6144
    buffer_load_dwordx4 v[104:107], v17, s[24:27], s70 offen nt
    s_add_u32 s70, s70, 6144
    buffer_load_dwordx4 v[108:111], v17, s[24:27], s70 offen nt
    s_add_u32 s70, s70, 6144
    buffer_load_dwordx4 v[112:115], v17, s[24:27], s70 offen nt
    s_add_u32 s70, s70, 6144
    buffer_load_dwordx4 v[116:119], v17, s[24:27], s70 offen nt
    s_add_u32 s70, s70, 6144
    buffer_load_dwordx4 v[120:123], v17, s[24:27], s70 offen nt
    s_add_u32 s70, s70, 6144
    buffer_load_dwordx4 v[124:127], v17, s[24:27], s70 offen nt
L_XLD:
    s_mov_b32 s28, s64
    s_mov_b32 s29, s65
    s_mov_b32 s30, 0x400
    s_mov_b32 s31, 0x20000
    buffer_load_dwordx4 v[28:31], v60, s[28:31], 0 offen
    buffer_load_dword v32, v33, s[28:31], s71 offen
    s_mov_b32 s28, s48
    s_mov_b32 s29, s49
    s_mov_b32 s30, 0x400000
    s_mov_b32 s31, 0x20000
    s_lshl_b32 s71, s37, 19
    s_lshl_b32 s45, s36, 8
    s_add_u32 s71, s71, s45
    buffer_load_dwordx4 v[128:131], v62, s[28:31], s71 offen nt
    s_add_u32 s71, s71, 8192
    buffer_load_dwordx4 v[132:135], v62, s[28:31], s71 offen nt
    s_add_u32 s71, s71, 57344
    buffer_load_dwordx4 v[136:139], v62, s[28:31], s71 offen nt
    s_add_u32 s71, s71, 8192
    buffer_load_dwordx4 v[140:143], v62, s[28:31], s71 offen nt
    s_add_u32 s71, s71, 57344
    buffer_load_dwordx4 v[144:147], v62, s[28:31], s71 offen nt
    s_add_u32 s71, s71, 8192
    buffer_load_dwordx4 v[148:151], v62, s[28:31], s71 offen nt
    s_add_u32 s71, s71, 57344
    buffer_load_dwordx4 v[152:155], v62, s[28:31], s71 offen nt
    s_add_u32 s71, s71, 8192
    buffer_load_dwordx4 v[156:159], v62, s[28:31], s71 offen nt
    s_add_u32 s71, s71, 57344
    buffer_load_dwordx4 v[160:163], v62, s[28:31], s71 offen nt
    s_add_u32 s71, s71, 8192
    buffer_load_dwordx4 v[164:167], v62, s[28:31], s71 offen nt
    s_add_u32 s71, s71, 57344
    buffer_load_dwordx4 v[168:171], v62, s[28:31], s71 offen nt
    s_add_u32 s71, s71, 8192
    buffer_load_dwordx4 v[172:175], v62, s[28:31], s71 offen nt
    s_add_u32 s71, s71, 57344
    buffer_load_dwordx4 v[176:179], v62, s[28:31], s71 offen nt
    s_add_u32 s71, s71, 8192
    buffer_load_dwordx4 v[180:183], v62, s[28:31], s71 offen nt
    s_add_u32 s71, s71, 57344
    buffer_load_dwordx4 v[184:187], v62, s[28:31], s71 offen nt
    s_add_u32 s71, s71, 8192
    buffer_load_dwordx4 v[188:191], v62, s[28:31], s71 offen nt
L_B0:
    s_branch L_CW
L_VPART:
    s_mov_b32 s12, s6
    s_mov_b32 s13, s7
    s_mov_b32 s14, 0x2000000
    s_mov_b32 s15, 0x20000
    s_mov_b32 s76, s78
    s_mov_b32 s77, s72
    s_add_u32 s70, s76, s77
    s_lshr_b32 s70, s70, 2
    s_add_u32 s70, s70, s69
    s_lshl_b32 s45, s3, 3
    s_add_u32 s45, s45, 0x21100
    v_mov_b32 v1, s45
    v_mov_b32 v2, 1
    s_waitcnt vmcnt(5)
    buffer_load_dwordx4 v[128:131], v12, s[12:15], s70 offen nt
    s_waitcnt vmcnt(5)
    s_add_u32 s70, s70, 262144
    buffer_load_dwordx4 v[132:135], v12, s[12:15], s70 offen nt
    s_waitcnt vmcnt(5)
    s_add_u32 s70, s70, 262144
    buffer_load_dwordx4 v[136:139], v12, s[12:15], s70 offen nt
    s_waitcnt vmcnt(5)
    s_add_u32 s70, s70, 262144
    buffer_load_dwordx4 v[140:143], v12, s[12:15], s70 offen nt
    s_add_u32 s76, s76, 0x20000
    s_and_b32 s76, s76, 0xe0000
    s_add_u32 s77, s77, 32768
    s_and_b32 s77, s77, 126976
    s_add_u32 s70, s76, s77
    s_lshr_b32 s70, s70, 2
    s_add_u32 s70, s70, s69
    s_waitcnt vmcnt(5)
    buffer_load_dwordx4 v[144:147], v12, s[12:15], s70 offen nt
    s_waitcnt vmcnt(5)
    ds_write_b32 v1, v2
    s_add_u32 s70, s70, 262144
    buffer_load_dwordx4 v[148:151], v12, s[12:15], s70 offen nt
    s_waitcnt vmcnt(5)
    s_add_u32 s70, s70, 262144
    buffer_load_dwordx4 v[152:155], v12, s[12:15], s70 offen nt
    s_waitcnt vmcnt(5)
    s_add_u32 s70, s70, 262144
    buffer_load_dwordx4 v[156:159], v12, s[12:15], s70 offen nt
    s_add_u32 s76, s76, 0x20000
    s_and_b32 s76, s76, 0xe0000
    s_add_u32 s77, s77, 32768
    s_and_b32 s77, s77, 126976
    s_add_u32 s70, s76, s77
    s_lshr_b32 s70, s70, 2
    s_add_u32 s70, s70, s69
    s_waitcnt vmcnt(5)
    buffer_load_dwordx4 v[160:163], v12, s[12:15], s70 offen nt
    s_waitcnt vmcnt(5)
    s_add_u32 s70, s70, 262144
    buffer_load_dwordx4 v[164:167], v12, s[12:15], s70 offen nt
    s_waitcnt vmcnt(5)
    s_add_u32 s70, s70, 262144
    buffer_load_dwordx4 v[168:171], v12, s[12:15], s70 offen nt
    s_waitcnt vmcnt(5)
    s_add_u32 s70, s70, 262144
    buffer_load_dwordx4 v[172:175], v12, s[12:15], s70 offen nt
    s_add_u32 s76, s76, 0x20000
    s_and_b32 s76, s76, 0xe0000
    s_add_u32 s77, s77, 32768
    s_and_b32 s77, s77, 126976
    s_add_u32 s70, s76, s77
    s_lshr_b32 s70, s70, 2
    s_add_u32 s70, s70, s69
    s_waitcnt vmcnt(8)
    buffer_load_dwordx4 v[176:179], v12, s[12:15], s70 offen nt
    s_waitcnt vmcnt(8)
    s_add_u32 s70, s70, 262144
    buffer_load_dwordx4 v[180:183], v12, s[12:15], s70 offen nt
    s_waitcnt vmcnt(8)
    s_add_u32 s70, s70, 262144
    buffer_load_dwordx4 v[184:187], v12, s[12:15], s70 offen nt
    s_waitcnt vmcnt(8)
    s_add_u32 s70, s70, 262144
    buffer_load_dwordx4 v[188:191], v12, s[12:15], s70 offen nt
    s_add_u32 s76, s76, 0x20000
    s_and_b32 s76, s76, 0xe0000
    s_add_u32 s77, s77, 32768
    s_and_b32 s77, s77, 126976
    s_add_u32 s70, s76, s77
    s_lshr_b32 s70, s70, 2
    s_add_u32 s70, s70, s69
    s_waitcnt vmcnt(8)
    buffer_load_dwordx4 v[192:195], v12, s[12:15], s70 offen nt
    s_waitcnt vmcnt(8)
    s_add_u32 s70, s70, 262144
    buffer_load_dwordx4 v[196:199], v12, s[12:15], s70 offen nt
    s_waitcnt vmcnt(8)
    s_add_u32 s70, s70, 262144
    buffer_load_dwordx4 v[200:203], v12, s[12:15], s70 offen nt
    s_waitcnt vmcnt(8)
    s_add_u32 s70, s70, 262144
    buffer_load_dwordx4 v[204:207], v12, s[12:15], s70 offen nt
    s_add_u32 s76, s76, 0x20000
    s_and_b32 s76, s76, 0xe0000
    s_add_u32 s77, s77, 32768
    s_and_b32 s77, s77, 126976
    s_add_u32 s70, s76, s77
    s_lshr_b32 s70, s70, 2
    s_add_u32 s70, s70, s69
    s_waitcnt vmcnt(8)
    buffer_load_dwordx4 v[208:211], v12, s[12:15], s70 offen nt
    s_waitcnt vmcnt(8)
    s_add_u32 s70, s70, 262144
    buffer_load_dwordx4 v[212:215], v12, s[12:15], s70 offen nt
    s_waitcnt vmcnt(8)
    s_add_u32 s70, s70, 262144
    buffer_load_dwordx4 v[216:219], v12, s[12:15], s70 offen nt
    s_waitcnt vmcnt(8)
    s_add_u32 s70, s70, 262144
    buffer_load_dwordx4 v[220:223], v12, s[12:15], s70 offen nt
    s_add_u32 s76, s76, 0x20000
    s_and_b32 s76, s76, 0xe0000
    s_add_u32 s77, s77, 32768
    s_and_b32 s77, s77, 126976
    s_add_u32 s70, s76, s77
    s_lshr_b32 s70, s70, 2
    s_add_u32 s70, s70, s69
    s_waitcnt vmcnt(8)
    buffer_load_dwordx4 v[224:227], v12, s[12:15], s70 offen nt
    s_waitcnt vmcnt(8)
    s_add_u32 s70, s70, 262144
    buffer_load_dwordx4 v[228:231], v12, s[12:15], s70 offen nt
    s_waitcnt vmcnt(8)
    s_add_u32 s70, s70, 262144
    buffer_load_dwordx4 v[232:235], v12, s[12:15], s70 offen nt
    s_waitcnt vmcnt(8)
    s_add_u32 s70, s70, 262144
    buffer_load_dwordx4 v[236:239], v12, s[12:15], s70 offen nt
    s_add_u32 s76, s76, 0x20000
    s_and_b32 s76, s76, 0xe0000
    s_add_u32 s77, s77, 32768
    s_and_b32 s77, s77, 126976
    s_add_u32 s70, s76, s77
    s_lshr_b32 s70, s70, 2
    s_add_u32 s70, s70, s69
    s_waitcnt vmcnt(8)
    buffer_load_dwordx4 v[240:243], v12, s[12:15], s70 offen nt
    s_waitcnt vmcnt(8)
    s_add_u32 s70, s70, 262144
    buffer_load_dwordx4 v[244:247], v12, s[12:15], s70 offen nt
    s_waitcnt vmcnt(8)
    s_add_u32 s70, s70, 262144
    buffer_load_dwordx4 v[248:251], v12, s[12:15], s70 offen nt
    s_waitcnt vmcnt(8)
    s_add_u32 s70, s70, 262144
    buffer_load_dwordx4 v[252:255], v12, s[12:15], s70 offen nt
    v_and_b32 v1, 1, v0
    v_lshlrev_b32 v1, 4, v1
    v_mov_b32 v2, 0xffff
    v_lshlrev_b32 v2, v1, v2
    v_bfe_u32 v1, v0, 1, 2
    v_cmp_eq_u32 vcc, 0, v1
    s_nop 1
    v_cndmask_b32 v4, 0, v2, vcc
    v_cmp_eq_u32 vcc, 1, v1
    s_nop 1
    v_cndmask_b32 v5, 0, v2, vcc
    v_cmp_eq_u32 vcc, 2, v1
    s_nop 1
    v_cndmask_b32 v6, 0, v2, vcc
    v_cmp_eq_u32 vcc, 3, v1
    s_nop 1
    v_cndmask_b32 v7, 0, v2, vcc
    v_lshrrev_b32 v1, 4, v0
    v_lshlrev_b32 v1, 4, v1
    s_lshl_b32 s45, s3, 9
    s_add_u32 s45, s45, 0x20000
    v_add_u32 v13, s45, v1
    s_add_u32 s45, s45, 0x800
    v_lshlrev_b32 v1, 3, v0
    v_add_u32 v14, s45, v1
    s_waitcnt lgkmcnt(0)
    s_barrier
    ds_read_b128 v[16:19], v13 offset:0
    ds_read_b128 v[20:23], v13 offset:64
    ds_read_b128 v[24:27], v13 offset:128
    ds_read_b128 v[28:31], v13 offset:192
    ds_read_b128 v[32:35], v13 offset:256
    ds_read_b128 v[36:39], v13 offset:320
    ds_read_b128 v[40:43], v13 offset:384
    ds_read_b128 v[44:47], v13 offset:448
    s_waitcnt lgkmcnt(7)
    v_and_b32 v48, v16, v4
    v_and_b32 v49, v16, v5
    v_and_b32 v50, v16, v6
    v_and_b32 v51, v16, v7
    v_and_b32 v52, v17, v4
    v_and_b32 v53, v17, v5
    v_and_b32 v54, v17, v6
    v_and_b32 v55, v17, v7
    s_waitcnt vmcnt(31)
    v_mfma_f32_16x16x32_bf16 v[56:59], v[48:51], v[128:131], 0
    v_and_b32 v48, v18, v4
    v_and_b32 v49, v18, v5
    v_and_b32 v50, v18, v6
    v_and_b32 v51, v18, v7
    s_waitcnt vmcnt(30)
    v_mfma_f32_16x16x32_bf16 v[56:59], v[52:55], v[132:135], v[56:59]
    v_and_b32 v52, v19, v4
    v_and_b32 v53, v19, v5
    v_and_b32 v54, v19, v6
    v_and_b32 v55, v19, v7
    s_waitcnt vmcnt(29)
    v_mfma_f32_16x16x32_bf16 v[56:59], v[48:51], v[136:139], v[56:59]
    s_waitcnt lgkmcnt(6)
    v_and_b32 v48, v20, v4
    v_and_b32 v49, v20, v5
    v_and_b32 v50, v20, v6
    v_and_b32 v51, v20, v7
    s_waitcnt vmcnt(28)
    v_mfma_f32_16x16x32_bf16 v[56:59], v[52:55], v[140:143], v[56:59]
    v_and_b32 v52, v21, v4
    v_and_b32 v53, v21, v5
    v_and_b32 v54, v21, v6
    v_and_b32 v55, v21, v7
    s_waitcnt vmcnt(27)
    v_mfma_f32_16x16x32_bf16 v[56:59], v[48:51], v[144:147], v[56:59]
    v_and_b32 v48, v22, v4
    v_and_b32 v49, v22, v5
    v_and_b32 v50, v22, v6
    v_and_b32 v51, v22, v7
    s_waitcnt vmcnt(26)
    v_mfma_f32_16x16x32_bf16 v[56:59], v[52:55], v[148:151], v[56:59]
    v_and_b32 v52, v23, v4
    v_and_b32 v53, v23, v5
    v_and_b32 v54, v23, v6
    v_and_b32 v55, v23, v7
    s_waitcnt vmcnt(25)
    v_mfma_f32_16x16x32_bf16 v[56:59], v[48:51], v[152:155], v[56:59]
    s_waitcnt lgkmcnt(5)
    v_and_b32 v48, v24, v4
    v_and_b32 v49, v24, v5
    v_and_b32 v50, v24, v6
    v_and_b32 v51, v24, v7
    s_waitcnt vmcnt(24)
    v_mfma_f32_16x16x32_bf16 v[56:59], v[52:55], v[156:159], v[56:59]
    v_and_b32 v52, v25, v4
    v_and_b32 v53, v25, v5
    v_and_b32 v54, v25, v6
    v_and_b32 v55, v25, v7
    s_waitcnt vmcnt(23)
    v_mfma_f32_16x16x32_bf16 v[56:59], v[48:51], v[160:163], v[56:59]
    v_and_b32 v48, v26, v4
    v_and_b32 v49, v26, v5
    v_and_b32 v50, v26, v6
    v_and_b32 v51, v26, v7
    s_waitcnt vmcnt(22)
    v_mfma_f32_16x16x32_bf16 v[56:59], v[52:55], v[164:167], v[56:59]
    v_and_b32 v52, v27, v4
    v_and_b32 v53, v27, v5
    v_and_b32 v54, v27, v6
    v_and_b32 v55, v27, v7
    s_waitcnt vmcnt(21)
    v_mfma_f32_16x16x32_bf16 v[56:59], v[48:51], v[168:171], v[56:59]
    s_waitcnt lgkmcnt(4)
    v_and_b32 v48, v28, v4
    v_and_b32 v49, v28, v5
    v_and_b32 v50, v28, v6
    v_and_b32 v51, v28, v7
    s_waitcnt vmcnt(20)
    v_mfma_f32_16x16x32_bf16 v[56:59], v[52:55], v[172:175], v[56:59]
    v_and_b32 v52, v29, v4
    v_and_b32 v53, v29, v5
    v_and_b32 v54, v29, v6
    v_and_b32 v55, v29, v7
    s_waitcnt vmcnt(19)
    v_mfma_f32_16x16x32_bf16 v[56:59], v[48:51], v[176:179], v[56:59]
    v_and_b32 v48, v30, v4
    v_and_b32 v49, v30, v5
    v_and_b32 v50, v30, v6
    v_and_b32 v51, v30, v7
    s_waitcnt vmcnt(18)
    v_mfma_f32_16x16x32_bf16 v[56:59], v[52:55], v[180:183], v[56:59]
    v_and_b32 v52, v31, v4
    v_and_b32 v53, v31, v5
    v_and_b32 v54, v31, v6
    v_and_b32 v55, v31, v7
    s_waitcnt vmcnt(17)
    v_mfma_f32_16x16x32_bf16 v[56:59], v[48:51], v[184:187], v[56:59]
    s_waitcnt lgkmcnt(3)
    v_and_b32 v48, v32, v4
    v_and_b32 v49, v32, v5
    v_and_b32 v50, v32, v6
    v_and_b32 v51, v32, v7
    s_waitcnt vmcnt(16)
    v_mfma_f32_16x16x32_bf16 v[56:59], v[52:55], v[188:191], v[56:59]
    v_and_b32 v52, v33, v4
    v_and_b32 v53, v33, v5
    v_and_b32 v54, v33, v6
    v_and_b32 v55, v33, v7
    s_waitcnt vmcnt(15)
    v_mfma_f32_16x16x32_bf16 v[56:59], v[48:51], v[192:195], v[56:59]
    v_and_b32 v48, v34, v4
    v_and_b32 v49, v34, v5
    v_and_b32 v50, v34, v6
    v_and_b32 v51, v34, v7
    s_waitcnt vmcnt(14)
    v_mfma_f32_16x16x32_bf16 v[56:59], v[52:55], v[196:199], v[56:59]
    v_and_b32 v52, v35, v4
    v_and_b32 v53, v35, v5
    v_and_b32 v54, v35, v6
    v_and_b32 v55, v35, v7
    s_waitcnt vmcnt(13)
    v_mfma_f32_16x16x32_bf16 v[56:59], v[48:51], v[200:203], v[56:59]
    s_waitcnt lgkmcnt(2)
    v_and_b32 v48, v36, v4
    v_and_b32 v49, v36, v5
    v_and_b32 v50, v36, v6
    v_and_b32 v51, v36, v7
    s_waitcnt vmcnt(12)
    v_mfma_f32_16x16x32_bf16 v[56:59], v[52:55], v[204:207], v[56:59]
    v_and_b32 v52, v37, v4
    v_and_b32 v53, v37, v5
    v_and_b32 v54, v37, v6
    v_and_b32 v55, v37, v7
    s_waitcnt vmcnt(11)
    v_mfma_f32_16x16x32_bf16 v[56:59], v[48:51], v[208:211], v[56:59]
    v_and_b32 v48, v38, v4
    v_and_b32 v49, v38, v5
    v_and_b32 v50, v38, v6
    v_and_b32 v51, v38, v7
    s_waitcnt vmcnt(10)
    v_mfma_f32_16x16x32_bf16 v[56:59], v[52:55], v[212:215], v[56:59]
    v_and_b32 v52, v39, v4
    v_and_b32 v53, v39, v5
    v_and_b32 v54, v39, v6
    v_and_b32 v55, v39, v7
    s_waitcnt vmcnt(9)
    v_mfma_f32_16x16x32_bf16 v[56:59], v[48:51], v[216:219], v[56:59]
    s_waitcnt lgkmcnt(1)
    v_and_b32 v48, v40, v4
    v_and_b32 v49, v40, v5
    v_and_b32 v50, v40, v6
    v_and_b32 v51, v40, v7
    s_waitcnt vmcnt(8)
    v_mfma_f32_16x16x32_bf16 v[56:59], v[52:55], v[220:223], v[56:59]
    v_and_b32 v52, v41, v4
    v_and_b32 v53, v41, v5
    v_and_b32 v54, v41, v6
    v_and_b32 v55, v41, v7
    s_waitcnt vmcnt(7)
    v_mfma_f32_16x16x32_bf16 v[56:59], v[48:51], v[224:227], v[56:59]
    v_and_b32 v48, v42, v4
    v_and_b32 v49, v42, v5
    v_and_b32 v50, v42, v6
    v_and_b32 v51, v42, v7
    s_waitcnt vmcnt(6)
    v_mfma_f32_16x16x32_bf16 v[56:59], v[52:55], v[228:231], v[56:59]
    v_and_b32 v52, v43, v4
    v_and_b32 v53, v43, v5
    v_and_b32 v54, v43, v6
    v_and_b32 v55, v43, v7
    s_waitcnt vmcnt(5)
    v_mfma_f32_16x16x32_bf16 v[56:59], v[48:51], v[232:235], v[56:59]
    s_waitcnt lgkmcnt(0)
    v_and_b32 v48, v44, v4
    v_and_b32 v49, v44, v5
    v_and_b32 v50, v44, v6
    v_and_b32 v51, v44, v7
    s_waitcnt vmcnt(4)
    v_mfma_f32_16x16x32_bf16 v[56:59], v[52:55], v[236:239], v[56:59]
    v_and_b32 v52, v45, v4
    v_and_b32 v53, v45, v5
    v_and_b32 v54, v45, v6
    v_and_b32 v55, v45, v7
    s_waitcnt vmcnt(3)
    v_mfma_f32_16x16x32_bf16 v[56:59], v[48:51], v[240:243], v[56:59]
    v_and_b32 v48, v46, v4
    v_and_b32 v49, v46, v5
    v_and_b32 v50, v46, v6
    v_and_b32 v51, v46, v7
    s_waitcnt vmcnt(2)
    v_mfma_f32_16x16x32_bf16 v[56:59], v[52:55], v[244:247], v[56:59]
    v_and_b32 v52, v47, v4
    v_and_b32 v53, v47, v5
    v_and_b32 v54, v47, v6
    v_and_b32 v55, v47, v7
    s_waitcnt vmcnt(1)
    v_mfma_f32_16x16x32_bf16 v[56:59], v[48:51], v[248:251], v[56:59]
    s_waitcnt vmcnt(0)
    v_mfma_f32_16x16x32_bf16 v[56:59], v[52:55], v[252:255], v[56:59]
    s_nop 7
    v_permlane32_swap_b32 v56, v58
    v_permlane32_swap_b32 v57, v59
    ds_write_b64 v14, v[56:57]
    s_waitcnt lgkmcnt(0)
    s_barrier
    s_endpgm
L_CW:
    s_barrier
    s_setprio 3
    s_cmp_eq_u32 s3, 4
    s_cbranch_scc0 L_C123
    s_load_dword s42, s[40:41], 0
    s_mov_b32 s16, s40
    s_mov_b32 s17, s41
    s_mov_b32 s18, 0x300000
    s_mov_b32 s19, 0x20000
    v_and_b32 v1, 1, v0
    v_lshlrev_b32 v1, 4, v1
    v_mov_b32 v2, 0xffff
    v_lshlrev_b32 v2, v1, v2
    v_bfe_u32 v1, v0, 1, 2
    v_cmp_eq_u32 vcc, 0, v1
    s_nop 1
    v_cndmask_b32 v4, 0, v2, vcc
    v_cmp_eq_u32 vcc, 1, v1
    s_nop 1
    v_cndmask_b32 v5, 0, v2, vcc
    v_cmp_eq_u32 vcc, 2, v1
    s_nop 1
    v_cndmask_b32 v6, 0, v2, vcc
    v_cmp_eq_u32 vcc, 3, v1
    s_nop 1
    v_cndmask_b32 v7, 0, v2, vcc
    s_waitcnt lgkmcnt(0)
    s_add_u32 s42, s42, 1
    s_getreg_b32 s73, hwreg(HW_REG_XCC_ID, 0, 3)
    s_lshl_b32 s45, s42, 3
    s_or_b32 s73, s73, s45
    s_lshl_b32 s72, s36, 7
    s_add_u32 s72, s72, 0x1d000
    s_lshl_b32 s45, s37, 2
    s_add_u32 s45, s45, s72
    v_mov_b32 v1, s45
    v_mov_b32 v2, s73
    s_lshl_b32 s44, s38, 3
    s_lshr_b32 s45, s39, 2
    s_add_u32 s44, s44, s45
    s_lshl_b32 s44, s44, 7
    s_add_u32 s44, s44, 0x194000
    s_and_b32 s45, s39, 3
    s_lshl_b32 s45, s45, 2
    s_add_u32 s45, s45, s44
    v_writelane_b32 v1, s45, 1
    s_lshl_b32 s45, s38, 7
    s_lshl_b32 s71, s39, 2
    s_add_u32 s45, s45, s71
    s_add_u32 s45, s45, 0x1a000
    v_writelane_b32 v1, s45, 2
    s_mov_b64 exec, 7
    buffer_store_dword v2, v1, s[16:19], 0 offen sc1
    s_mov_b64 exec, -1
    s_cmp_lt_u32 s47, 8
    s_cbranch_scc0 L_NOT1
    s_lshl_b32 s71, s35, 3
    s_add_u32 s71, s71, s47
    s_lshl_b32 s71, s71, 9
    s_add_u32 s71, s71, 0x1000
    s_waitcnt vmcnt(35)
    v_lshlrev_b32 v40, 16, v18
    v_and_b32 v41, 0xffff0000, v18
    v_mul_f32 v42, 0xbfb8aa3b, v40
    v_mul_f32 v43, 0xbfb8aa3b, v41
    v_exp_f32 v42, v42
    v_exp_f32 v43, v43
    v_add_f32 v42, 1.0, v42
    v_add_f32 v43, 1.0, v43
    v_rcp_f32 v42, v42
    v_rcp_f32 v43, v43
    v_mul_f32 v40, v40, v42
    v_mul_f32 v41, v41, v43
    v_cvt_pk_bf16_f32 v40, v40, v40
    v_cvt_pk_bf16_f32 v41, v41, v41
    v_mov_b32 v42, v40
    v_mov_b32 v43, v41
    s_nop 0
    v_mov_b32_dpp v42, v40 row_shl:4 row_mask:0xf bank_mask:0x5
    v_mov_b32_dpp v43, v41 row_shl:4 row_mask:0xf bank_mask:0x5
    v_mov_b32_dpp v40, v40 row_shr:4 row_mask:0xf bank_mask:0xa
    v_mov_b32_dpp v41, v41 row_shr:4 row_mask:0xf bank_mask:0xa
    s_waitcnt vmcnt(19)
    v_and_b32_dpp v52, v40, v4 quad_perm:[0,0,0,0] row_mask:0xf bank_mask:0xf
    v_and_b32_dpp v53, v40, v5 quad_perm:[0,0,0,0] row_mask:0xf bank_mask:0xf
    v_and_b32_dpp v54, v40, v6 quad_perm:[0,0,0,0] row_mask:0xf bank_mask:0xf
    v_and_b32_dpp v55, v40, v7 quad_perm:[0,0,0,0] row_mask:0xf bank_mask:0xf
    v_and_b32_dpp v56, v41, v4 quad_perm:[0,0,0,0] row_mask:0xf bank_mask:0xf
    v_and_b32_dpp v57, v41, v5 quad_perm:[0,0,0,0] row_mask:0xf bank_mask:0xf
    v_and_b32_dpp v58, v41, v6 quad_perm:[0,0,0,0] row_mask:0xf bank_mask:0xf
    v_and_b32_dpp v59, v41, v7 quad_perm:[0,0,0,0] row_mask:0xf bank_mask:0xf
    v_mfma_f32_16x16x32_bf16 v[36:39], v[52:55], v[64:67], 0
    v_and_b32_dpp v52, v40, v4 quad_perm:[1,1,1,1] row_mask:0xf bank_mask:0xf
    v_and_b32_dpp v53, v40, v5 quad_perm:[1,1,1,1] row_mask:0xf bank_mask:0xf
    v_and_b32_dpp v54, v40, v6 quad_perm:[1,1,1,1] row_mask:0xf bank_mask:0xf
    v_and_b32_dpp v55, v40, v7 quad_perm:[1,1,1,1] row_mask:0xf bank_mask:0xf
    v_mfma_f32_16x16x32_bf16 v[36:39], v[56:59], v[68:71], v[36:39]
    v_and_b32_dpp v56, v41, v4 quad_perm:[1,1,1,1] row_mask:0xf bank_mask:0xf
    v_and_b32_dpp v57, v41, v5 quad_perm:[1,1,1,1] row_mask:0xf bank_mask:0xf
    v_and_b32_dpp v58, v41, v6 quad_perm:[1,1,1,1] row_mask:0xf bank_mask:0xf
    v_and_b32_dpp v59, v41, v7 quad_perm:[1,1,1,1] row_mask:0xf bank_mask:0xf
    v_mfma_f32_16x16x32_bf16 v[36:39], v[52:55], v[72:75], v[36:39]
    v_and_b32_dpp v52, v40, v4 quad_perm:[2,2,2,2] row_mask:0xf bank_mask:0xf
    v_and_b32_dpp v53, v40, v5 quad_perm:[2,2,2,2] row_mask:0xf bank_mask:0xf
    v_and_b32_dpp v54, v40, v6 quad_perm:[2,2,2,2] row_mask:0xf bank_mask:0xf
    v_and_b32_dpp v55, v40, v7 quad_perm:[2,2,2,2] row_mask:0xf bank_mask:0xf
    v_mfma_f32_16x16x32_bf16 v[36:39], v[56:59], v[76:79], v[36:39]
    v_and_b32_dpp v56, v41, v4 quad_perm:[2,2,2,2] row_mask:0xf bank_mask:0xf
    v_and_b32_dpp v57, v41, v5 quad_perm:[2,2,2,2] row_mask:0xf bank_mask:0xf
    v_and_b32_dpp v58, v41, v6 quad_perm:[2,2,2,2] row_mask:0xf bank_mask:0xf
    v_and_b32_dpp v59, v41, v7 quad_perm:[2,2,2,2] row_mask:0xf bank_mask:0xf
    v_mfma_f32_16x16x32_bf16 v[36:39], v[52:55], v[80:83], v[36:39]
    v_and_b32_dpp v52, v40, v4 quad_perm:[3,3,3,3] row_mask:0xf bank_mask:0xf
    v_and_b32_dpp v53, v40, v5 quad_perm:[3,3,3,3] row_mask:0xf bank_mask:0xf
    v_and_b32_dpp v54, v40, v6 quad_perm:[3,3,3,3] row_mask:0xf bank_mask:0xf
    v_and_b32_dpp v55, v40, v7 quad_perm:[3,3,3,3] row_mask:0xf bank_mask:0xf
    v_mfma_f32_16x16x32_bf16 v[36:39], v[56:59], v[84:87], v[36:39]
    v_and_b32_dpp v56, v41, v4 quad_perm:[3,3,3,3] row_mask:0xf bank_mask:0xf
    v_and_b32_dpp v57, v41, v5 quad_perm:[3,3,3,3] row_mask:0xf bank_mask:0xf
    v_and_b32_dpp v58, v41, v6 quad_perm:[3,3,3,3] row_mask:0xf bank_mask:0xf
    v_and_b32_dpp v59, v41, v7 quad_perm:[3,3,3,3] row_mask:0xf bank_mask:0xf
    v_mfma_f32_16x16x32_bf16 v[36:39], v[52:55], v[88:91], v[36:39]
    v_and_b32_dpp v52, v42, v4 quad_perm:[0,0,0,0] row_mask:0xf bank_mask:0xf
    v_and_b32_dpp v53, v42, v5 quad_perm:[0,0,0,0] row_mask:0xf bank_mask:0xf
    v_and_b32_dpp v54, v42, v6 quad_perm:[0,0,0,0] row_mask:0xf bank_mask:0xf
    v_and_b32_dpp v55, v42, v7 quad_perm:[0,0,0,0] row_mask:0xf bank_mask:0xf
    v_mfma_f32_16x16x32_bf16 v[36:39], v[56:59], v[92:95], v[36:39]
    v_and_b32_dpp v56, v43, v4 quad_perm:[0,0,0,0] row_mask:0xf bank_mask:0xf
    v_and_b32_dpp v57, v43, v5 quad_perm:[0,0,0,0] row_mask:0xf bank_mask:0xf
    v_and_b32_dpp v58, v43, v6 quad_perm:[0,0,0,0] row_mask:0xf bank_mask:0xf
    v_and_b32_dpp v59, v43, v7 quad_perm:[0,0,0,0] row_mask:0xf bank_mask:0xf
    v_mfma_f32_16x16x32_bf16 v[36:39], v[52:55], v[96:99], v[36:39]
    v_and_b32_dpp v52, v42, v4 quad_perm:[1,1,1,1] row_mask:0xf bank_mask:0xf
    v_and_b32_dpp v53, v42, v5 quad_perm:[1,1,1,1] row_mask:0xf bank_mask:0xf
    v_and_b32_dpp v54, v42, v6 quad_perm:[1,1,1,1] row_mask:0xf bank_mask:0xf
    v_and_b32_dpp v55, v42, v7 quad_perm:[1,1,1,1] row_mask:0xf bank_mask:0xf
    v_mfma_f32_16x16x32_bf16 v[36:39], v[56:59], v[100:103], v[36:39]
    v_and_b32_dpp v56, v43, v4 quad_perm:[1,1,1,1] row_mask:0xf bank_mask:0xf
    v_and_b32_dpp v57, v43, v5 quad_perm:[1,1,1,1] row_mask:0xf bank_mask:0xf
    v_and_b32_dpp v58, v43, v6 quad_perm:[1,1,1,1] row_mask:0xf bank_mask:0xf
    v_and_b32_dpp v59, v43, v7 quad_perm:[1,1,1,1] row_mask:0xf bank_mask:0xf
    v_mfma_f32_16x16x32_bf16 v[36:39], v[52:55], v[104:107], v[36:39]
    v_and_b32_dpp v52, v42, v4 quad_perm:[2,2,2,2] row_mask:0xf bank_mask:0xf
    v_and_b32_dpp v53, v42, v5 quad_perm:[2,2,2,2] row_mask:0xf bank_mask:0xf
    v_and_b32_dpp v54, v42, v6 quad_perm:[2,2,2,2] row_mask:0xf bank_mask:0xf
    v_and_b32_dpp v55, v42, v7 quad_perm:[2,2,2,2] row_mask:0xf bank_mask:0xf
    v_mfma_f32_16x16x32_bf16 v[36:39], v[56:59], v[108:111], v[36:39]
    v_and_b32_dpp v56, v43, v4 quad_perm:[2,2,2,2] row_mask:0xf bank_mask:0xf
    v_and_b32_dpp v57, v43, v5 quad_perm:[2,2,2,2] row_mask:0xf bank_mask:0xf
    v_and_b32_dpp v58, v43, v6 quad_perm:[2,2,2,2] row_mask:0xf bank_mask:0xf
    v_and_b32_dpp v59, v43, v7 quad_perm:[2,2,2,2] row_mask:0xf bank_mask:0xf
    v_mfma_f32_16x16x32_bf16 v[36:39], v[52:55], v[112:115], v[36:39]
    v_and_b32_dpp v52, v42, v4 quad_perm:[3,3,3,3] row_mask:0xf bank_mask:0xf
    v_and_b32_dpp v53, v42, v5 quad_perm:[3,3,3,3] row_mask:0xf bank_mask:0xf
    v_and_b32_dpp v54, v42, v6 quad_perm:[3,3,3,3] row_mask:0xf bank_mask:0xf
    v_and_b32_dpp v55, v42, v7 quad_perm:[3,3,3,3] row_mask:0xf bank_mask:0xf
    v_mfma_f32_16x16x32_bf16 v[36:39], v[56:59], v[116:119], v[36:39]
    v_and_b32_dpp v56, v43, v4 quad_perm:[3,3,3,3] row_mask:0xf bank_mask:0xf
    v_and_b32_dpp v57, v43, v5 quad_perm:[3,3,3,3] row_mask:0xf bank_mask:0xf
    v_and_b32_dpp v58, v43, v6 quad_perm:[3,3,3,3] row_mask:0xf bank_mask:0xf
    v_and_b32_dpp v59, v43, v7 quad_perm:[3,3,3,3] row_mask:0xf bank_mask:0xf
    v_mfma_f32_16x16x32_bf16 v[36:39], v[52:55], v[120:123], v[36:39]
    s_nop 0
    v_mfma_f32_16x16x32_bf16 v[36:39], v[56:59], v[124:127], v[36:39]
    s_nop 7
    v_permlane32_swap_b32 v36, v38
    v_permlane32_swap_b32 v37, v39
    s_nop 0
    v_add_f32_dpp v36, v38, v36 row_ror:8 row_mask:0xf bank_mask:0xf
    v_add_f32_dpp v37, v39, v37 row_ror:8 row_mask:0xf bank_mask:0xf
    v_mov_b32 v38, s42
    s_mov_b32 exec_lo, 0xff00ff
    s_mov_b32 exec_hi, 0xff00ff
    buffer_store_dwordx4 v[36:39], v19, s[16:19], s71 offen sc1
    s_mov_b64 exec, -1
    s_lshl_b32 s71, s35, 9
    s_lshl_b32 s45, s47, 2
    s_add_u32 s71, s71, s45
    s_add_u32 s71, s71, 0x1b000
    v_lshlrev_b32 v1, 7, v0
    s_mov_b64 exec, 15
    buffer_store_dword v38, v1, s[16:19], s71 offen sc1
    s_mov_b64 exec, -1
    s_branch L_T1D
L_NOT1:
L_T1D:
    s_waitcnt vmcnt(17)
    v_lshlrev_b32 v64, 16, v28
    v_and_b32 v65, 0xffff0000, v28
    v_lshlrev_b32 v66, 16, v29
    v_and_b32 v67, 0xffff0000, v29
    v_lshlrev_b32 v68, 16, v30
    v_and_b32 v69, 0xffff0000, v30
    v_lshlrev_b32 v70, 16, v31
    v_and_b32 v71, 0xffff0000, v31
    v_add_f32 v20, v64, v65
    v_add_f32 v21, v66, v67
    v_add_f32 v22, v68, v69
    v_add_f32 v23, v70, v71
    v_add_f32 v20, v20, v21
    v_add_f32 v22, v22, v23
    v_add_f32 v20, v20, v22
    s_nop 1
    v_add_f32_dpp v20, v20, v20 quad_perm:[1,0,3,2] row_mask:0xf bank_mask:0xf
    s_nop 1
    v_add_f32_dpp v20, v20, v20 quad_perm:[2,3,0,1] row_mask:0xf bank_mask:0xf
    s_nop 1
    v_add_f32_dpp v20, v20, v20 row_ror:4 row_mask:0xf bank_mask:0xf
    s_nop 1
    v_add_f32_dpp v20, v20, v20 row_ror:8 row_mask:0xf bank_mask:0xf
    s_nop 1
    v_add_f32_dpp v20, v20, v20 row_bcast:15 row_mask:0xa bank_mask:0xf
    s_nop 1
    v_add_f32_dpp v20, v20, v20 row_bcast:31 row_mask:0xc bank_mask:0xf
    v_mul_f32 v20, 0x3b000000, v20
    s_nop 0
    v_readlane_b32 s45, v20, 63
    s_nop 1
    v_subrev_f32 v64, s45, v64
    v_subrev_f32 v65, s45, v65
    v_subrev_f32 v66, s45, v66
    v_subrev_f32 v67, s45, v67
    v_subrev_f32 v68, s45, v68
    v_subrev_f32 v69, s45, v69
    v_subrev_f32 v70, s45, v70
    v_subrev_f32 v71, s45, v71
    v_mul_f32 v21, v64, v64
    v_fmac_f32 v21, v65, v65
    v_fmac_f32 v21, v66, v66
    v_fmac_f32 v21, v67, v67
    v_fmac_f32 v21, v68, v68
    v_fmac_f32 v21, v69, v69
    v_fmac_f32 v21, v70, v70
    v_fmac_f32 v21, v71, v71
    s_nop 1
    v_add_f32_dpp v21, v21, v21 quad_perm:[1,0,3,2] row_mask:0xf bank_mask:0xf
    s_nop 1
    v_add_f32_dpp v21, v21, v21 quad_perm:[2,3,0,1] row_mask:0xf bank_mask:0xf
    s_nop 1
    v_add_f32_dpp v21, v21, v21 row_ror:4 row_mask:0xf bank_mask:0xf
    s_nop 1
    v_add_f32_dpp v21, v21, v21 row_ror:8 row_mask:0xf bank_mask:0xf
    s_nop 1
    v_add_f32_dpp v21, v21, v21 row_bcast:15 row_mask:0xa bank_mask:0xf
    s_nop 1
    v_add_f32_dpp v21, v21, v21 row_bcast:31 row_mask:0xc bank_mask:0xf
    v_mul_f32 v21, 0x3b000000, v21
    v_cvt_pk_bf16_f32 v22, v20, v21
    v_and_b32 v21, 0xffff0000, v22
    v_lshlrev_b32 v20, 16, v22
    v_add_f32 v21, 0x3727c5ac, v21
    v_cvt_pk_bf16_f32 v21, v21, v21
    v_and_b32 v21, 0xffff0000, v21
    v_sqrt_f32 v21, v21
    s_nop 0
    v_cvt_pk_bf16_f32 v21, v21, v21
    v_and_b32 v21, 0xffff0000, v21
    v_rcp_f32 v22, v21
    v_readlane_b32 s45, v20, 63
    v_readlane_b32 s46, v21, 63
    v_readlane_b32 s47, v22, 63
    v_lshlrev_b32 v24, 16, v32
    v_and_b32 v25, 0xffff0000, v32
    v_subrev_f32 v24, s45, v24
    v_subrev_f32 v25, s45, v25
    v_cvt_pk_bf16_f32 v20, v24, v25
    v_lshlrev_b32 v24, 16, v20
    v_and_b32 v25, 0xffff0000, v20
    v_mul_f32 v20, s47, v24
    v_mul_f32 v21, s47, v25
    v_fma_f32 v24, -v20, s46, v24
    v_fma_f32 v25, -v21, s46, v25
    v_fma_f32 v24, v24, s47, v20
    v_fma_f32 v25, v25, s47, v21
    v_cvt_pk_bf16_f32 v20, v24, v25
    v_lshlrev_b32 v24, 16, v20
    v_and_b32 v25, 0xffff0000, v20
    v_bfe_u32 v1, v0, 3, 1
    v_lshlrev_b32 v1, 9, v1
    v_add_u32 v26, v19, v1
    s_lshl_b32 s69, s37, 12
    s_add_u32 s69, s69, 0x1000
    s_lshl_b32 s45, s37, 2
    s_and_b32 s46, s36, 3
    s_add_u32 s45, s45, s46
    s_lshl_b32 s45, s45, 7
    s_add_u32 s45, s45, 0x1b000
    s_add_u32 s74, s40, s45
    s_addc_u32 s75, s41, 0
    s_mov_b32 s68, 0
L_h1h1:
    s_load_dwordx8 s[76:83], s[74:75], 0 glc
    s_add_u32 s68, s68, 1
    s_cmp_gt_u32 s68, 262144
    s_cbranch_scc1 L_END
    s_waitcnt lgkmcnt(0)
    s_xor_b32 s76, s76, s42
    s_xor_b32 s77, s77, s42
    s_or_b32 s76, s76, s77
    s_xor_b32 s78, s78, s42
    s_or_b32 s76, s76, s78
    s_xor_b32 s79, s79, s42
    s_or_b32 s76, s76, s79
    s_xor_b32 s80, s80, s42
    s_or_b32 s76, s76, s80
    s_xor_b32 s81, s81, s42
    s_or_b32 s76, s76, s81
    s_xor_b32 s82, s82, s42
    s_or_b32 s76, s76, s82
    s_xor_b32 s83, s83, s42
    s_or_b32 s76, s76, s83
    s_cbranch_scc0 L_h1hd2
    s_sleep 3
    s_branch L_h1h1
L_h1hd2:
    s_add_u32 s74, s40, s72
    s_addc_u32 s75, s41, 0
    s_load_dwordx8 s[76:83], s[74:75], 0 glc
    s_load_dwordx4 s[8:11], s[40:41], s44 glc
    s_mov_b32 s68, 0
L_h13:
    buffer_load_dwordx4 v[192:195], v26, s[16:19], s69 offen offset:0 sc1
    buffer_load_dwordx4 v[196:199], v26, s[16:19], s69 offen offset:1024 sc1
    buffer_load_dwordx4 v[200:203], v26, s[16:19], s69 offen offset:2048 sc1
    buffer_load_dwordx4 v[204:207], v26, s[16:19], s69 offen offset:3072 sc1
    s_add_u32 s68, s68, 1
    s_cmp_gt_u32 s68, 262144
    s_cbranch_scc1 L_END
    s_waitcnt vmcnt(0)
    v_xor_b32 v1, s42, v194
    v_xor_b32 v2, s42, v198
    v_bitop3_b32 v1, v202, s42, v1 bitop3:0xbe
    v_bitop3_b32 v2, v206, s42, v2 bitop3:0xbe
    v_or_b32 v1, v1, v2
    v_cmp_ne_u32 vcc, 0, v1
    s_cbranch_vccnz L_h13
    s_waitcnt lgkmcnt(0)
    s_xor_b32 s76, s76, s73
    s_xor_b32 s77, s77, s73
    s_or_b32 s76, s76, s77
    s_xor_b32 s78, s78, s73
    s_or_b32 s76, s76, s78
    s_xor_b32 s79, s79, s73
    s_or_b32 s76, s76, s79
    s_xor_b32 s80, s80, s73
    s_or_b32 s76, s76, s80
    s_xor_b32 s81, s81, s73
    s_or_b32 s76, s76, s81
    s_xor_b32 s82, s82, s73
    s_or_b32 s76, s76, s82
    s_xor_b32 s83, s83, s73
    s_or_b32 s76, s76, s83
    s_cselect_b32 s45, 0, 1
    s_xor_b32 s8, s8, s73
    s_xor_b32 s9, s9, s73
    s_or_b32 s8, s8, s9
    s_xor_b32 s10, s10, s73
    s_or_b32 s8, s8, s10
    s_xor_b32 s11, s11, s73
    s_or_b32 s8, s8, s11
    s_cselect_b32 s44, 0, 1
    s_mov_b32 s73, s45
    v_add_f32 v192, v192, v196
    v_add_f32 v200, v200, v204
    v_add_f32 v193, v193, v197
    v_add_f32 v201, v201, v205
    v_add_f32 v192, v192, v200
    v_add_f32 v193, v193, v201
    v_cvt_pk_bf16_f32 v196, v192, v193
    v_mov_b32 v197, v196
    s_nop 1
    v_mov_b32_dpp v196, v197 row_ror:8 row_mask:0xf bank_mask:0xc
    v_mov_b32_dpp v197, v197 row_ror:8 row_mask:0xf bank_mask:0x3
    v_lshlrev_b32 v200, 16, v196
    v_and_b32 v201, 0xffff0000, v196
    v_lshlrev_b32 v198, 16, v197
    v_and_b32 v199, 0xffff0000, v197
    v_add_f32 v198, 1.0, v198
    v_add_f32 v199, 1.0, v199
    v_cvt_pk_bf16_f32 v197, v198, v199
    v_lshlrev_b32 v198, 16, v197
    v_and_b32 v199, 0xffff0000, v197
    v_mul_f32 v198, v198, v24
    v_mul_f32 v199, v199, v25
    v_cvt_pk_bf16_f32 v197, v198, v199
    v_lshlrev_b32 v198, 16, v197
    v_and_b32 v199, 0xffff0000, v197
    v_add_f32 v198, v198, v200
    v_add_f32 v199, v199, v201
    v_cvt_pk_bf16_f32 v20, v198, v198
    v_cvt_pk_bf16_f32 v21, v199, v199
    s_lshl_b32 s70, s36, 13
    s_add_u32 s70, s70, 0x20000
    s_lshl_b32 s69, s37, 10
    s_add_u32 s69, s69, s70
    s_add_u32 s71, s70, 4096
    v_and_b32_dpp v52, v20, v4 row_newbcast:0 row_mask:0xf bank_mask:0xf
    v_and_b32_dpp v53, v20, v5 row_newbcast:0 row_mask:0xf bank_mask:0xf
    v_and_b32_dpp v54, v20, v6 row_newbcast:0 row_mask:0xf bank_mask:0xf
    v_and_b32_dpp v55, v20, v7 row_newbcast:0 row_mask:0xf bank_mask:0xf
    v_and_b32_dpp v56, v21, v4 row_newbcast:0 row_mask:0xf bank_mask:0xf
    v_and_b32_dpp v57, v21, v5 row_newbcast:0 row_mask:0xf bank_mask:0xf
    v_and_b32_dpp v58, v21, v6 row_newbcast:0 row_mask:0xf bank_mask:0xf
    v_and_b32_dpp v59, v21, v7 row_newbcast:0 row_mask:0xf bank_mask:0xf
    v_mfma_f32_16x16x32_bf16 v[36:39], v[52:55], v[128:131], 0
    v_and_b32_dpp v52, v20, v4 row_newbcast:1 row_mask:0xf bank_mask:0xf
    v_and_b32_dpp v53, v20, v5 row_newbcast:1 row_mask:0xf bank_mask:0xf
    v_and_b32_dpp v54, v20, v6 row_newbcast:1 row_mask:0xf bank_mask:0xf
    v_and_b32_dpp v55, v20, v7 row_newbcast:1 row_mask:0xf bank_mask:0xf
    v_mfma_f32_16x16x32_bf16 v[36:39], v[56:59], v[132:135], v[36:39]
    v_and_b32_dpp v56, v21, v4 row_newbcast:1 row_mask:0xf bank_mask:0xf
    v_and_b32_dpp v57, v21, v5 row_newbcast:1 row_mask:0xf bank_mask:0xf
    v_and_b32_dpp v58, v21, v6 row_newbcast:1 row_mask:0xf bank_mask:0xf
    v_and_b32_dpp v59, v21, v7 row_newbcast:1 row_mask:0xf bank_mask:0xf
    v_mfma_f32_16x16x32_bf16 v[36:39], v[52:55], v[136:139], v[36:39]
    v_and_b32_dpp v52, v20, v4 row_newbcast:2 row_mask:0xf bank_mask:0xf
    v_and_b32_dpp v53, v20, v5 row_newbcast:2 row_mask:0xf bank_mask:0xf
    v_and_b32_dpp v54, v20, v6 row_newbcast:2 row_mask:0xf bank_mask:0xf
    v_and_b32_dpp v55, v20, v7 row_newbcast:2 row_mask:0xf bank_mask:0xf
    v_mfma_f32_16x16x32_bf16 v[36:39], v[56:59], v[140:143], v[36:39]
    v_and_b32_dpp v56, v21, v4 row_newbcast:2 row_mask:0xf bank_mask:0xf
    v_and_b32_dpp v57, v21, v5 row_newbcast:2 row_mask:0xf bank_mask:0xf
    v_and_b32_dpp v58, v21, v6 row_newbcast:2 row_mask:0xf bank_mask:0xf
    v_and_b32_dpp v59, v21, v7 row_newbcast:2 row_mask:0xf bank_mask:0xf
    v_mfma_f32_16x16x32_bf16 v[36:39], v[52:55], v[144:147], v[36:39]
    v_and_b32_dpp v52, v20, v4 row_newbcast:3 row_mask:0xf bank_mask:0xf
    v_and_b32_dpp v53, v20, v5 row_newbcast:3 row_mask:0xf bank_mask:0xf
    v_and_b32_dpp v54, v20, v6 row_newbcast:3 row_mask:0xf bank_mask:0xf
    v_and_b32_dpp v55, v20, v7 row_newbcast:3 row_mask:0xf bank_mask:0xf
    v_mfma_f32_16x16x32_bf16 v[36:39], v[56:59], v[148:151], v[36:39]
    v_and_b32_dpp v56, v21, v4 row_newbcast:3 row_mask:0xf bank_mask:0xf
    v_and_b32_dpp v57, v21, v5 row_newbcast:3 row_mask:0xf bank_mask:0xf
    v_and_b32_dpp v58, v21, v6 row_newbcast:3 row_mask:0xf bank_mask:0xf
    v_and_b32_dpp v59, v21, v7 row_newbcast:3 row_mask:0xf bank_mask:0xf
    v_mfma_f32_16x16x32_bf16 v[36:39], v[52:55], v[152:155], v[36:39]
    v_and_b32_dpp v52, v20, v4 row_newbcast:4 row_mask:0xf bank_mask:0xf
    v_and_b32_dpp v53, v20, v5 row_newbcast:4 row_mask:0xf bank_mask:0xf
    v_and_b32_dpp v54, v20, v6 row_newbcast:4 row_mask:0xf bank_mask:0xf
    v_and_b32_dpp v55, v20, v7 row_newbcast:4 row_mask:0xf bank_mask:0xf
    v_mfma_f32_16x16x32_bf16 v[36:39], v[56:59], v[156:159], v[36:39]
    v_and_b32_dpp v56, v21, v4 row_newbcast:4 row_mask:0xf bank_mask:0xf
    v_and_b32_dpp v57, v21, v5 row_newbcast:4 row_mask:0xf bank_mask:0xf
    v_and_b32_dpp v58, v21, v6 row_newbcast:4 row_mask:0xf bank_mask:0xf
    v_and_b32_dpp v59, v21, v7 row_newbcast:4 row_mask:0xf bank_mask:0xf
    v_mfma_f32_16x16x32_bf16 v[36:39], v[52:55], v[160:163], v[36:39]
    v_and_b32_dpp v52, v20, v4 row_newbcast:5 row_mask:0xf bank_mask:0xf
    v_and_b32_dpp v53, v20, v5 row_newbcast:5 row_mask:0xf bank_mask:0xf
    v_and_b32_dpp v54, v20, v6 row_newbcast:5 row_mask:0xf bank_mask:0xf
    v_and_b32_dpp v55, v20, v7 row_newbcast:5 row_mask:0xf bank_mask:0xf
    v_mfma_f32_16x16x32_bf16 v[36:39], v[56:59], v[164:167], v[36:39]
    v_and_b32_dpp v56, v21, v4 row_newbcast:5 row_mask:0xf bank_mask:0xf
    v_and_b32_dpp v57, v21, v5 row_newbcast:5 row_mask:0xf bank_mask:0xf
    v_and_b32_dpp v58, v21, v6 row_newbcast:5 row_mask:0xf bank_mask:0xf
    v_and_b32_dpp v59, v21, v7 row_newbcast:5 row_mask:0xf bank_mask:0xf
    v_mfma_f32_16x16x32_bf16 v[36:39], v[52:55], v[168:171], v[36:39]
    v_and_b32_dpp v52, v20, v4 row_newbcast:6 row_mask:0xf bank_mask:0xf
    v_and_b32_dpp v53, v20, v5 row_newbcast:6 row_mask:0xf bank_mask:0xf
    v_and_b32_dpp v54, v20, v6 row_newbcast:6 row_mask:0xf bank_mask:0xf
    v_and_b32_dpp v55, v20, v7 row_newbcast:6 row_mask:0xf bank_mask:0xf
    v_mfma_f32_16x16x32_bf16 v[36:39], v[56:59], v[172:175], v[36:39]
    v_and_b32_dpp v56, v21, v4 row_newbcast:6 row_mask:0xf bank_mask:0xf
    v_and_b32_dpp v57, v21, v5 row_newbcast:6 row_mask:0xf bank_mask:0xf
    v_and_b32_dpp v58, v21, v6 row_newbcast:6 row_mask:0xf bank_mask:0xf
    v_and_b32_dpp v59, v21, v7 row_newbcast:6 row_mask:0xf bank_mask:0xf
    v_mfma_f32_16x16x32_bf16 v[36:39], v[52:55], v[176:179], v[36:39]
    v_and_b32_dpp v52, v20, v4 row_newbcast:7 row_mask:0xf bank_mask:0xf
    v_and_b32_dpp v53, v20, v5 row_newbcast:7 row_mask:0xf bank_mask:0xf
    v_and_b32_dpp v54, v20, v6 row_newbcast:7 row_mask:0xf bank_mask:0xf
    v_and_b32_dpp v55, v20, v7 row_newbcast:7 row_mask:0xf bank_mask:0xf
    v_mfma_f32_16x16x32_bf16 v[36:39], v[56:59], v[180:183], v[36:39]
    v_and_b32_dpp v56, v21, v4 row_newbcast:7 row_mask:0xf bank_mask:0xf
    v_and_b32_dpp v57, v21, v5 row_newbcast:7 row_mask:0xf bank_mask:0xf
    v_and_b32_dpp v58, v21, v6 row_newbcast:7 row_mask:0xf bank_mask:0xf
    v_and_b32_dpp v59, v21, v7 row_newbcast:7 row_mask:0xf bank_mask:0xf
    v_mfma_f32_16x16x32_bf16 v[36:39], v[52:55], v[184:187], v[36:39]
    s_nop 0
    v_mfma_f32_16x16x32_bf16 v[36:39], v[56:59], v[188:191], v[36:39]
    s_nop 7
    v_permlane32_swap_b32 v36, v38
    v_permlane32_swap_b32 v37, v39
    v_mov_b32 v38, s42
    s_cmp_eq_u32 s73, 1
    s_cbranch_scc0 L_far4
    buffer_store_dwordx4 v[36:39], v60, s[16:19], s69 offen
    s_branch L_pb5
L_far4:
    buffer_store_dwordx4 v[36:39], v60, s[16:19], s69 offen sc1
L_pb5:
    s_lshl_b32 s72, s36, 7
    s_add_u32 s72, s72, 0x1c000
    v_mov_b32 v1, 0
    s_lshl_b32 s45, s37, 2
    s_add_u32 s45, s45, s72
    s_mov_b64 exec, 1
    buffer_store_dword v38, v1, s[16:19], s45 offen sc1
    s_mov_b64 exec, -1
    v_bfe_u32 v1, v0, 4, 1
    v_lshrrev_b32 v2, 5, v0
    v_lshl_add_u32 v1, v1, 1, v2
    v_and_b32 v2, 15, v0
    v_lshl_add_u32 v1, v2, 2, v1
    v_lshlrev_b32 v1, 2, v1
    v_add_u32 v26, 0x21000, v1
    v_and_b32 v27, 3, v0
    v_lshlrev_b32 v27, 3, v27
    v_add_u32 v27, 0x21104, v27
    v_mov_b32 v25, 1
    s_add_u32 s74, s40, s72
    s_addc_u32 s75, s41, 0
    s_mov_b32 s68, 0
L_qh6:
    s_load_dwordx8 s[76:83], s[74:75], 0 glc
    s_add_u32 s68, s68, 1
    s_cmp_gt_u32 s68, 262144
    s_cbranch_scc1 L_END
    s_waitcnt lgkmcnt(0)
    s_xor_b32 s76, s76, s42
    s_xor_b32 s77, s77, s42
    s_or_b32 s76, s76, s77
    s_xor_b32 s78, s78, s42
    s_or_b32 s76, s76, s78
    s_xor_b32 s79, s79, s42
    s_or_b32 s76, s76, s79
    s_xor_b32 s80, s80, s42
    s_or_b32 s76, s76, s80
    s_xor_b32 s81, s81, s42
    s_or_b32 s76, s76, s81
    s_xor_b32 s82, s82, s42
    s_or_b32 s76, s76, s82
    s_xor_b32 s83, s83, s42
    s_or_b32 s76, s76, s83
    s_cbranch_scc0 L_qhd7
    s_sleep 3
    s_branch L_qh6
L_qhd7:
    s_mov_b32 s68, 0
L_q8:
    buffer_load_dwordx4 v[192:195], v60, s[16:19], s70 offen offset:0 sc1
    buffer_load_dwordx4 v[196:199], v60, s[16:19], s70 offen offset:1024 sc1
    buffer_load_dwordx4 v[200:203], v60, s[16:19], s70 offen offset:2048 sc1
    buffer_load_dwordx4 v[204:207], v60, s[16:19], s70 offen offset:3072 sc1
    buffer_load_dwordx4 v[208:211], v60, s[16:19], s71 offen offset:0 sc1
    buffer_load_dwordx4 v[212:215], v60, s[16:19], s71 offen offset:1024 sc1
    buffer_load_dwordx4 v[216:219], v60, s[16:19], s71 offen offset:2048 sc1
    buffer_load_dwordx4 v[220:223], v60, s[16:19], s71 offen offset:3072 sc1
    s_add_u32 s68, s68, 1
    s_cmp_gt_u32 s68, 262144
    s_cbranch_scc1 L_END
    s_waitcnt vmcnt(0)
    v_xor_b32 v1, s42, v194
    v_xor_b32 v2, s42, v198
    v_bitop3_b32 v1, v202, s42, v1 bitop3:0xbe
    v_bitop3_b32 v2, v206, s42, v2 bitop3:0xbe
    v_bitop3_b32 v1, v210, s42, v1 bitop3:0xbe
    v_bitop3_b32 v2, v214, s42, v2 bitop3:0xbe
    v_bitop3_b32 v1, v218, s42, v1 bitop3:0xbe
    v_bitop3_b32 v2, v222, s42, v2 bitop3:0xbe
    v_or_b32 v1, v1, v2
    v_cmp_ne_u32 vcc, 0, v1
    s_cbranch_vccnz L_q8
    v_add_f32 v192, v192, v196
    v_add_f32 v193, v193, v197
    v_add_f32 v200, v200, v204
    v_add_f32 v201, v201, v205
    v_add_f32 v208, v208, v212
    v_add_f32 v209, v209, v213
    v_add_f32 v216, v216, v220
    v_add_f32 v217, v217, v221
    v_add_f32 v192, v192, v200
    v_add_f32 v193, v193, v201
    v_add_f32 v208, v208, v216
    v_add_f32 v209, v209, v217
    v_add_f32 v192, v192, v208
    v_add_f32 v193, v193, v209
    v_cvt_pk_bf16_f32 v1, v192, v193
    ds_write_b32 v26, v1
    ds_write_b32 v27, v25
L_QKP:
    s_sub_u32 s47, s3, 4
    s_lshl_b32 s45, s47, 3
    s_add_u32 s45, s45, 0x21100
    v_mov_b32 v3, s45
    v_and_b32 v1, 15, v0
    v_lshrrev_b32 v2, 4, v0
    v_lshlrev_b32 v26, 4, v2
    v_xor_b32 v2, v2, v1
    v_lshlrev_b32 v2, 4, v2
    v_and_b32 v8, 3, v0
    v_lshlrev_b32 v8, 10, v8
    v_lshrrev_b32 v1, 2, v1
    v_lshl_add_u32 v8, v1, 8, v8
    v_add_u32 v8, v8, v2
    s_lshl_b32 s45, s47, 15
    v_add_u32 v8, s45, v8
    v_xor_b32 v9, 64, v8
    v_xor_b32 v10, 128, v8
    v_xor_b32 v11, 192, v8
    v_and_b32 v27, 7, v0
    v_lshl_add_u32 v27, v27, 6, v26
    v_bfe_u32 v1, v0, 3, 1
    v_lshl_add_u32 v27, v1, 3, v27
    s_lshl_b32 s45, s47, 9
    s_add_u32 s45, s45, 0x20000
    v_add_u32 v27, s45, v27
    v_add_u32 v26, 0x21000, v26
    s_lshl_b32 s45, s47, 4
    s_add_u32 s45, s45, 0x21140
    v_mov_b32 v25, s45
    v_mov_b32 v218, 1
    v_mov_b32 v219, 1
    s_mov_b32 s74, 0x00010001
    s_mov_b32 s75, 0x00010001
    s_mov_b32 s76, 0x01000100
    s_mov_b32 s77, 0x01000100
    s_mov_b32 s68, 0
L_kq9:
    ds_read_b64 v[28:29], v3
    s_add_u32 s68, s68, 1
    s_cmp_gt_u32 s68, 2097152
    s_cbranch_scc1 L_END
    s_waitcnt lgkmcnt(0)
    v_and_b32 v1, v28, v29
    v_cmp_eq_u32 vcc, 0, v1
    s_cbranch_vccz L_kqd10
    s_sleep 1
    s_branch L_kq9
L_kqd10:
    ds_read_b128 v[128:131], v26 offset:0
    ds_read_b128 v[132:135], v26 offset:64
    ds_read_b128 v[136:139], v26 offset:128
    ds_read_b128 v[140:143], v26 offset:192
    ds_read_b128 v[144:147], v8 offset:0
    ds_read_b128 v[148:151], v9 offset:0
    ds_read_b128 v[152:155], v10 offset:0
    ds_read_b128 v[156:159], v11 offset:0
    ds_read_b128 v[160:163], v8 offset:4096
    ds_read_b128 v[164:167], v9 offset:4096
    ds_read_b128 v[168:171], v10 offset:4096
    ds_read_b128 v[172:175], v11 offset:4096
    s_waitcnt lgkmcnt(6)
    v_mfma_f32_16x16x32_bf16 v[28:31], v[144:147], v[128:131], 0
    ds_read_b128 v[176:179], v8 offset:8192
    v_mfma_f32_16x16x32_bf16 v[28:31], v[148:151], v[132:135], v[28:31]
    ds_read_b128 v[180:183], v9 offset:8192
    s_waitcnt lgkmcnt(6)
    v_mfma_f32_16x16x32_bf16 v[28:31], v[152:155], v[136:139], v[28:31]
    ds_read_b128 v[184:187], v10 offset:8192
    v_mfma_f32_16x16x32_bf16 v[28:31], v[156:159], v[140:143], v[28:31]
    ds_read_b128 v[188:191], v11 offset:8192
    s_waitcnt lgkmcnt(6)
    v_mfma_f32_16x16x32_bf16 v[32:35], v[160:163], v[128:131], 0
    ds_read_b128 v[144:147], v8 offset:12288
    v_mfma_f32_16x16x32_bf16 v[32:35], v[164:167], v[132:135], v[32:35]
    ds_read_b128 v[148:151], v9 offset:12288
    s_waitcnt lgkmcnt(6)
    v_mfma_f32_16x16x32_bf16 v[32:35], v[168:171], v[136:139], v[32:35]
    ds_read_b128 v[152:155], v10 offset:12288
    v_cndmask_b32 v208, v208, v28, s[74:75]
    v_cndmask_b32 v209, v209, v29, s[74:75]
    v_mfma_f32_16x16x32_bf16 v[32:35], v[172:175], v[140:143], v[32:35]
    ds_read_b128 v[156:159], v11 offset:12288
    v_cndmask_b32 v208, v208, v30, s[76:77]
    v_cndmask_b32 v209, v209, v31, s[76:77]
    s_lshl_b64 s[74:75], s[74:75], 1
    s_lshl_b64 s[76:77], s[76:77], 1
    s_waitcnt lgkmcnt(6)
    v_mfma_f32_16x16x32_bf16 v[28:31], v[176:179], v[128:131], 0
    ds_read_b128 v[160:163], v8 offset:16384
    v_mfma_f32_16x16x32_bf16 v[28:31], v[180:183], v[132:135], v[28:31]
    ds_read_b128 v[164:167], v9 offset:16384
    s_waitcnt lgkmcnt(6)
    v_mfma_f32_16x16x32_bf16 v[28:31], v[184:187], v[136:139], v[28:31]
    ds_read_b128 v[168:171], v10 offset:16384
    v_cndmask_b32 v208, v208, v32, s[74:75]
    v_cndmask_b32 v209, v209, v33, s[74:75]
    v_mfma_f32_16x16x32_bf16 v[28:31], v[188:191], v[140:143], v[28:31]
    ds_read_b128 v[172:175], v11 offset:16384
    v_cndmask_b32 v208, v208, v34, s[76:77]
    v_cndmask_b32 v209, v209, v35, s[76:77]
    s_lshl_b64 s[74:75], s[74:75], 1
    s_lshl_b64 s[76:77], s[76:77], 1
    s_waitcnt lgkmcnt(6)
    v_mfma_f32_16x16x32_bf16 v[32:35], v[144:147], v[128:131], 0
    ds_read_b128 v[176:179], v8 offset:20480
    v_mfma_f32_16x16x32_bf16 v[32:35], v[148:151], v[132:135], v[32:35]
    ds_read_b128 v[180:183], v9 offset:20480
    s_waitcnt lgkmcnt(6)
    v_mfma_f32_16x16x32_bf16 v[32:35], v[152:155], v[136:139], v[32:35]
    ds_read_b128 v[184:187], v10 offset:20480
    v_cndmask_b32 v208, v208, v28, s[74:75]
    v_cndmask_b32 v209, v209, v29, s[74:75]
    v_mfma_f32_16x16x32_bf16 v[32:35], v[156:159], v[140:143], v[32:35]
    ds_read_b128 v[188:191], v11 offset:20480
    v_cndmask_b32 v208, v208, v30, s[76:77]
    v_cndmask_b32 v209, v209, v31, s[76:77]
    s_lshl_b64 s[74:75], s[74:75], 1
    s_lshl_b64 s[76:77], s[76:77], 1
    s_waitcnt lgkmcnt(6)
    v_mfma_f32_16x16x32_bf16 v[28:31], v[160:163], v[128:131], 0
    ds_read_b128 v[144:147], v8 offset:24576
    v_mfma_f32_16x16x32_bf16 v[28:31], v[164:167], v[132:135], v[28:31]
    ds_read_b128 v[148:151], v9 offset:24576
    s_waitcnt lgkmcnt(6)
    v_mfma_f32_16x16x32_bf16 v[28:31], v[168:171], v[136:139], v[28:31]
    ds_read_b128 v[152:155], v10 offset:24576
    v_cndmask_b32 v208, v208, v32, s[74:75]
    v_cndmask_b32 v209, v209, v33, s[74:75]
    v_mfma_f32_16x16x32_bf16 v[28:31], v[172:175], v[140:143], v[28:31]
    ds_read_b128 v[156:159], v11 offset:24576
    v_cndmask_b32 v208, v208, v34, s[76:77]
    v_cndmask_b32 v209, v209, v35, s[76:77]
    s_lshl_b64 s[74:75], s[74:75], 1
    s_lshl_b64 s[76:77], s[76:77], 1
    s_waitcnt lgkmcnt(6)
    v_mfma_f32_16x16x32_bf16 v[32:35], v[176:179], v[128:131], 0
    ds_read_b128 v[160:163], v8 offset:28672
    v_mfma_f32_16x16x32_bf16 v[32:35], v[180:183], v[132:135], v[32:35]
    ds_read_b128 v[164:167], v9 offset:28672
    s_waitcnt lgkmcnt(6)
    v_mfma_f32_16x16x32_bf16 v[32:35], v[184:187], v[136:139], v[32:35]
    ds_read_b128 v[168:171], v10 offset:28672
    v_cndmask_b32 v208, v208, v28, s[74:75]
    v_cndmask_b32 v209, v209, v29, s[74:75]
    v_mfma_f32_16x16x32_bf16 v[32:35], v[188:191], v[140:143], v[32:35]
    ds_read_b128 v[172:175], v11 offset:28672
    v_cndmask_b32 v208, v208, v30, s[76:77]
    v_cndmask_b32 v209, v209, v31, s[76:77]
    s_lshl_b64 s[74:75], s[74:75], 1
    s_lshl_b64 s[76:77], s[76:77], 1
    s_waitcnt lgkmcnt(6)
    v_mfma_f32_16x16x32_bf16 v[28:31], v[144:147], v[128:131], 0
    v_mfma_f32_16x16x32_bf16 v[28:31], v[148:151], v[132:135], v[28:31]
    s_waitcnt lgkmcnt(4)
    v_mfma_f32_16x16x32_bf16 v[28:31], v[152:155], v[136:139], v[28:31]
    v_cndmask_b32 v208, v208, v32, s[74:75]
    v_cndmask_b32 v209, v209, v33, s[74:75]
    v_mfma_f32_16x16x32_bf16 v[28:31], v[156:159], v[140:143], v[28:31]
    v_cndmask_b32 v208, v208, v34, s[76:77]
    v_cndmask_b32 v209, v209, v35, s[76:77]
    s_lshl_b64 s[74:75], s[74:75], 1
    s_lshl_b64 s[76:77], s[76:77], 1
    s_waitcnt lgkmcnt(2)
    v_mfma_f32_16x16x32_bf16 v[32:35], v[160:163], v[128:131], 0
    v_mfma_f32_16x16x32_bf16 v[32:35], v[164:167], v[132:135], v[32:35]
    s_waitcnt lgkmcnt(0)
    v_mfma_f32_16x16x32_bf16 v[32:35], v[168:171], v[136:139], v[32:35]
    v_cndmask_b32 v208, v208, v28, s[74:75]
    v_cndmask_b32 v209, v209, v29, s[74:75]
    v_mfma_f32_16x16x32_bf16 v[32:35], v[172:175], v[140:143], v[32:35]
    v_cndmask_b32 v208, v208, v30, s[76:77]
    v_cndmask_b32 v209, v209, v31, s[76:77]
    s_lshl_b64 s[74:75], s[74:75], 1
    s_lshl_b64 s[76:77], s[76:77], 1
    s_nop 3
    v_cndmask_b32 v208, v208, v32, s[74:75]
    v_cndmask_b32 v209, v209, v33, s[74:75]
    v_cndmask_b32 v208, v208, v34, s[76:77]
    v_cndmask_b32 v209, v209, v35, s[76:77]
    v_cvt_pk_bf16_f32 v210, v208, v209
    v_lshlrev_b32 v208, 16, v210
    v_and_b32 v209, 0xffff0000, v210
    v_mul_f32 v208, 0x3db504f3, v208
    v_mul_f32 v209, 0x3db504f3, v209
    v_cvt_pk_bf16_f32 v210, v208, v209
    v_lshlrev_b32 v208, 16, v210
    v_and_b32 v209, 0xffff0000, v210
    v_max_f32 v216, v208, v209
    s_nop 1
    v_max_f32_dpp v216, v216, v216 quad_perm:[1,0,3,2] row_mask:0xf bank_mask:0xf
    s_nop 1
    v_max_f32_dpp v216, v216, v216 quad_perm:[2,3,0,1] row_mask:0xf bank_mask:0xf
    s_nop 1
    v_max_f32_dpp v216, v216, v216 row_ror:4 row_mask:0xf bank_mask:0xf
    s_nop 1
    v_max_f32_dpp v216, v216, v216 row_ror:8 row_mask:0xf bank_mask:0xf
    s_nop 1
    v_max_f32_dpp v216, v216, v216 row_bcast:15 row_mask:0xa bank_mask:0xf
    s_nop 1
    v_max_f32_dpp v216, v216, v216 row_bcast:31 row_mask:0xc bank_mask:0xf
    s_nop 0
    v_readlane_b32 s45, v216, 63
    s_nop 1
    v_subrev_f32 v210, s45, v208
    v_subrev_f32 v211, s45, v209
    v_mul_f32 v210, 0x3fb8aa3b, v210
    v_mul_f32 v211, 0x3fb8aa3b, v211
    v_exp_f32 v210, v210
    v_exp_f32 v211, v211
    s_nop 0
    v_add_f32 v217, v210, v211
    s_nop 1
    v_add_f32_dpp v217, v217, v217 quad_perm:[1,0,3,2] row_mask:0xf bank_mask:0xf
    s_nop 1
    v_add_f32_dpp v217, v217, v217 quad_perm:[2,3,0,1] row_mask:0xf bank_mask:0xf
    s_nop 1
    v_add_f32_dpp v217, v217, v217 row_ror:4 row_mask:0xf bank_mask:0xf
    s_nop 1
    v_add_f32_dpp v217, v217, v217 row_ror:8 row_mask:0xf bank_mask:0xf
    s_nop 1
    v_add_f32_dpp v217, v217, v217 row_bcast:15 row_mask:0xa bank_mask:0xf
    s_nop 1
    v_add_f32_dpp v217, v217, v217 row_bcast:31 row_mask:0xc bank_mask:0xf
    s_mov_b32 exec_lo, 0x0
    s_mov_b32 exec_hi, 0x80000000
    ds_write_b128 v25, v[216:219]
    s_mov_b64 exec, -1
    s_cmp_eq_u32 s3, 4
    s_cbranch_scc1 L_C0ML
    s_cmp_eq_u32 s3, 5
    s_cbranch_scc0 L_MLWAIT
    s_sub_u32 s45, s39, 8
    s_cmp_lt_u32 s45, 8
    s_cbranch_scc0 L_NORED
    s_sub_u32 s45, s39, 8
    s_mov_b32 s76, s45
    s_lshl_b32 s44, s38, 3
    s_add_u32 s44, s44, s45
    s_lshl_b32 s46, s38, 7
    s_add_u32 s46, s46, 0x1a000
    s_add_u32 s74, s40, s46
    s_addc_u32 s75, s41, 0
    s_load_dwordx16 s[4:19], s[74:75], 0 glc
    s_load_dwordx16 s[20:35], s[74:75], 64 glc
    s_getreg_b32 s73, hwreg(HW_REG_XCC_ID, 0, 3)
    s_lshl_b32 s46, s42, 3
    s_or_b32 s73, s73, s46
    v_lshlrev_b32 v16, 4, v0
    v_and_b32 v15, 3, v0
    v_lshlrev_b32 v15, 4, v15
    v_and_b32 v1, 7, v0
    v_lshlrev_b32 v1, 4, v1
    v_bfe_u32 v2, v0, 3, 1
    v_lshl_add_u32 v1, v2, 3, v1
    v_bfe_u32 v2, v0, 4, 1
    v_lshl_add_u32 v1, v2, 2, v1
    v_lshrrev_b32 v2, 5, v0
    v_lshl_add_u32 v3, v2, 1, v1
    v_bfe_u32 v1, v0, 4, 1
    v_lshlrev_b32 v1, 7, v1
    v_lshrrev_b32 v2, 2, v15
    v_add_u32 v18, v1, v2
    s_lshl_b32 s46, s38, 4
    v_add_u32 v18, s46, v18
    v_lshrrev_b32 v1, 4, v0
    v_lshl_add_u32 v17, v1, 14, v15
    v_bfe_u32 v1, v0, 2, 2
    v_lshl_add_u32 v17, v1, 11, v17
    s_waitcnt lgkmcnt(0)
    s_xor_b32 s4, s4, s73
    s_xor_b32 s5, s5, s73
    s_or_b32 s4, s4, s5
    s_xor_b32 s6, s6, s73
    s_or_b32 s4, s4, s6
    s_xor_b32 s7, s7, s73
    s_or_b32 s4, s4, s7
    s_xor_b32 s8, s8, s73
    s_or_b32 s4, s4, s8
    s_xor_b32 s9, s9, s73
    s_or_b32 s4, s4, s9
    s_xor_b32 s10, s10, s73
    s_or_b32 s4, s4, s10
    s_xor_b32 s11, s11, s73
    s_or_b32 s4, s4, s11
    s_xor_b32 s12, s12, s73
    s_or_b32 s4, s4, s12
    s_xor_b32 s13, s13, s73
    s_or_b32 s4, s4, s13
    s_xor_b32 s14, s14, s73
    s_or_b32 s4, s4, s14
    s_xor_b32 s15, s15, s73
    s_or_b32 s4, s4, s15
    s_xor_b32 s16, s16, s73
    s_or_b32 s4, s4, s16
    s_xor_b32 s17, s17, s73
    s_or_b32 s4, s4, s17
    s_xor_b32 s18, s18, s73
    s_or_b32 s4, s4, s18
    s_xor_b32 s19, s19, s73
    s_or_b32 s4, s4, s19
    s_xor_b32 s20, s20, s73
    s_or_b32 s4, s4, s20
    s_xor_b32 s21, s21, s73
    s_or_b32 s4, s4, s21
    s_xor_b32 s22, s22, s73
    s_or_b32 s4, s4, s22
    s_xor_b32 s23, s23, s73
    s_or_b32 s4, s4, s23
    s_xor_b32 s24, s24, s73
    s_or_b32 s4, s4, s24
    s_xor_b32 s25, s25, s73
    s_or_b32 s4, s4, s25
    s_xor_b32 s26, s26, s73
    s_or_b32 s4, s4, s26
    s_xor_b32 s27, s27, s73
    s_or_b32 s4, s4, s27
    s_xor_b32 s28, s28, s73
    s_or_b32 s4, s4, s28
    s_xor_b32 s29, s29, s73
    s_or_b32 s4, s4, s29
    s_xor_b32 s30, s30, s73
    s_or_b32 s4, s4, s30
    s_xor_b32 s31, s31, s73
    s_or_b32 s4, s4, s31
    s_xor_b32 s32, s32, s73
    s_or_b32 s4, s4, s32
    s_xor_b32 s33, s33, s73
    s_or_b32 s4, s4, s33
    s_xor_b32 s34, s34, s73
    s_or_b32 s4, s4, s34
    s_xor_b32 s35, s35, s73
    s_or_b32 s4, s4, s35
    s_cselect_b32 s73, 0, 1
    s_mov_b32 s16, s40
    s_mov_b32 s17, s41
    s_mov_b32 s18, 0x300000
    s_mov_b32 s19, 0x20000
    s_mov_b32 s20, s64
    s_mov_b32 s21, s65
    s_mov_b32 s22, 0x400
    s_mov_b32 s23, 0x20000
    s_mov_b32 s24, s66
    s_mov_b32 s25, s67
    s_mov_b32 s26, 0x400
    s_mov_b32 s27, 0x20000
    s_lshl_b32 s46, s76, 7
    buffer_load_ushort v12, v3, s[20:23], s46 offen
    s_and_b32 s47, s38, 1
    s_lshl_b32 s47, s47, 6
    s_add_u32 s46, s46, s47
    s_and_b32 s47, s38, 2
    s_lshl_b32 s47, s47, 2
    s_add_u32 s46, s46, s47
    s_and_b32 s47, s38, 4
    s_add_u32 s78, s46, s47
    s_lshl_b32 s4, s76, 11
    s_add_u32 s4, s4, 0x9000
    s_lshl_b32 s5, s76, 11
    s_add_u32 s5, s5, 0xd000
    s_lshl_b32 s6, s76, 11
    s_add_u32 s6, s6, 0x11000
    s_lshl_b32 s7, s76, 11
    s_add_u32 s7, s7, 0x15000
    v_mov_b32 v200, 0
    v_mov_b32 v201, 0
    v_mov_b32 v202, s42
    s_branch L_MLWAIT
L_NORED:
    s_cmp_eq_u32 s44, 99
    s_cbranch_scc0 L_MLWAIT
    s_waitcnt vmcnt(16)
    v_lshlrev_b32 v40, 16, v18
    v_and_b32 v41, 0xffff0000, v18
    v_mul_f32 v42, 0xbfb8aa3b, v40
    v_mul_f32 v43, 0xbfb8aa3b, v41
    v_exp_f32 v42, v42
    v_exp_f32 v43, v43
    v_add_f32 v42, 1.0, v42
    v_add_f32 v43, 1.0, v43
    v_rcp_f32 v42, v42
    v_rcp_f32 v43, v43
    v_mul_f32 v40, v40, v42
    v_mul_f32 v41, v41, v43
    v_cvt_pk_bf16_f32 v40, v40, v40
    v_cvt_pk_bf16_f32 v41, v41, v41
    v_mov_b32 v42, v40
    v_mov_b32 v43, v41
    s_nop 0
    v_mov_b32_dpp v42, v40 row_shl:4 row_mask:0xf bank_mask:0x5
    v_mov_b32_dpp v43, v41 row_shl:4 row_mask:0xf bank_mask:0x5
    v_mov_b32_dpp v40, v40 row_shr:4 row_mask:0xf bank_mask:0xa
    v_mov_b32_dpp v41, v41 row_shr:4 row_mask:0xf bank_mask:0xa
    s_waitcnt vmcnt(0)
    v_and_b32_dpp v52, v40, v4 quad_perm:[0,0,0,0] row_mask:0xf bank_mask:0xf
    v_and_b32_dpp v53, v40, v5 quad_perm:[0,0,0,0] row_mask:0xf bank_mask:0xf
    v_and_b32_dpp v54, v40, v6 quad_perm:[0,0,0,0] row_mask:0xf bank_mask:0xf
    v_and_b32_dpp v55, v40, v7 quad_perm:[0,0,0,0] row_mask:0xf bank_mask:0xf
    v_and_b32_dpp v56, v41, v4 quad_perm:[0,0,0,0] row_mask:0xf bank_mask:0xf
    v_and_b32_dpp v57, v41, v5 quad_perm:[0,0,0,0] row_mask:0xf bank_mask:0xf
    v_and_b32_dpp v58, v41, v6 quad_perm:[0,0,0,0] row_mask:0xf bank_mask:0xf
    v_and_b32_dpp v59, v41, v7 quad_perm:[0,0,0,0] row_mask:0xf bank_mask:0xf
    v_mfma_f32_16x16x32_bf16 v[36:39], v[52:55], v[64:67], 0
    v_and_b32_dpp v52, v40, v4 quad_perm:[1,1,1,1] row_mask:0xf bank_mask:0xf
    v_and_b32_dpp v53, v40, v5 quad_perm:[1,1,1,1] row_mask:0xf bank_mask:0xf
    v_and_b32_dpp v54, v40, v6 quad_perm:[1,1,1,1] row_mask:0xf bank_mask:0xf
    v_and_b32_dpp v55, v40, v7 quad_perm:[1,1,1,1] row_mask:0xf bank_mask:0xf
    v_mfma_f32_16x16x32_bf16 v[36:39], v[56:59], v[68:71], v[36:39]
    v_and_b32_dpp v56, v41, v4 quad_perm:[1,1,1,1] row_mask:0xf bank_mask:0xf
    v_and_b32_dpp v57, v41, v5 quad_perm:[1,1,1,1] row_mask:0xf bank_mask:0xf
    v_and_b32_dpp v58, v41, v6 quad_perm:[1,1,1,1] row_mask:0xf bank_mask:0xf
    v_and_b32_dpp v59, v41, v7 quad_perm:[1,1,1,1] row_mask:0xf bank_mask:0xf
    v_mfma_f32_16x16x32_bf16 v[36:39], v[52:55], v[72:75], v[36:39]
    v_and_b32_dpp v52, v40, v4 quad_perm:[2,2,2,2] row_mask:0xf bank_mask:0xf
    v_and_b32_dpp v53, v40, v5 quad_perm:[2,2,2,2] row_mask:0xf bank_mask:0xf
    v_and_b32_dpp v54, v40, v6 quad_perm:[2,2,2,2] row_mask:0xf bank_mask:0xf
    v_and_b32_dpp v55, v40, v7 quad_perm:[2,2,2,2] row_mask:0xf bank_mask:0xf
    v_mfma_f32_16x16x32_bf16 v[36:39], v[56:59], v[76:79], v[36:39]
    v_and_b32_dpp v56, v41, v4 quad_perm:[2,2,2,2] row_mask:0xf bank_mask:0xf
    v_and_b32_dpp v57, v41, v5 quad_perm:[2,2,2,2] row_mask:0xf bank_mask:0xf
    v_and_b32_dpp v58, v41, v6 quad_perm:[2,2,2,2] row_mask:0xf bank_mask:0xf
    v_and_b32_dpp v59, v41, v7 quad_perm:[2,2,2,2] row_mask:0xf bank_mask:0xf
    v_mfma_f32_16x16x32_bf16 v[36:39], v[52:55], v[80:83], v[36:39]
    v_and_b32_dpp v52, v40, v4 quad_perm:[3,3,3,3] row_mask:0xf bank_mask:0xf
    v_and_b32_dpp v53, v40, v5 quad_perm:[3,3,3,3] row_mask:0xf bank_mask:0xf
    v_and_b32_dpp v54, v40, v6 quad_perm:[3,3,3,3] row_mask:0xf bank_mask:0xf
    v_and_b32_dpp v55, v40, v7 quad_perm:[3,3,3,3] row_mask:0xf bank_mask:0xf
    v_mfma_f32_16x16x32_bf16 v[36:39], v[56:59], v[84:87], v[36:39]
    v_and_b32_dpp v56, v41, v4 quad_perm:[3,3,3,3] row_mask:0xf bank_mask:0xf
    v_and_b32_dpp v57, v41, v5 quad_perm:[3,3,3,3] row_mask:0xf bank_mask:0xf
    v_and_b32_dpp v58, v41, v6 quad_perm:[3,3,3,3] row_mask:0xf bank_mask:0xf
    v_and_b32_dpp v59, v41, v7 quad_perm:[3,3,3,3] row_mask:0xf bank_mask:0xf
    v_mfma_f32_16x16x32_bf16 v[36:39], v[52:55], v[88:91], v[36:39]
    v_and_b32_dpp v52, v42, v4 quad_perm:[0,0,0,0] row_mask:0xf bank_mask:0xf
    v_and_b32_dpp v53, v42, v5 quad_perm:[0,0,0,0] row_mask:0xf bank_mask:0xf
    v_and_b32_dpp v54, v42, v6 quad_perm:[0,0,0,0] row_mask:0xf bank_mask:0xf
    v_and_b32_dpp v55, v42, v7 quad_perm:[0,0,0,0] row_mask:0xf bank_mask:0xf
    v_mfma_f32_16x16x32_bf16 v[36:39], v[56:59], v[92:95], v[36:39]
    v_and_b32_dpp v56, v43, v4 quad_perm:[0,0,0,0] row_mask:0xf bank_mask:0xf
    v_and_b32_dpp v57, v43, v5 quad_perm:[0,0,0,0] row_mask:0xf bank_mask:0xf
    v_and_b32_dpp v58, v43, v6 quad_perm:[0,0,0,0] row_mask:0xf bank_mask:0xf
    v_and_b32_dpp v59, v43, v7 quad_perm:[0,0,0,0] row_mask:0xf bank_mask:0xf
    v_mfma_f32_16x16x32_bf16 v[36:39], v[52:55], v[96:99], v[36:39]
    v_and_b32_dpp v52, v42, v4 quad_perm:[1,1,1,1] row_mask:0xf bank_mask:0xf
    v_and_b32_dpp v53, v42, v5 quad_perm:[1,1,1,1] row_mask:0xf bank_mask:0xf
    v_and_b32_dpp v54, v42, v6 quad_perm:[1,1,1,1] row_mask:0xf bank_mask:0xf
    v_and_b32_dpp v55, v42, v7 quad_perm:[1,1,1,1] row_mask:0xf bank_mask:0xf
    v_mfma_f32_16x16x32_bf16 v[36:39], v[56:59], v[100:103], v[36:39]
    v_and_b32_dpp v56, v43, v4 quad_perm:[1,1,1,1] row_mask:0xf bank_mask:0xf
    v_and_b32_dpp v57, v43, v5 quad_perm:[1,1,1,1] row_mask:0xf bank_mask:0xf
    v_and_b32_dpp v58, v43, v6 quad_perm:[1,1,1,1] row_mask:0xf bank_mask:0xf
    v_and_b32_dpp v59, v43, v7 quad_perm:[1,1,1,1] row_mask:0xf bank_mask:0xf
    v_mfma_f32_16x16x32_bf16 v[36:39], v[52:55], v[104:107], v[36:39]
    v_and_b32_dpp v52, v42, v4 quad_perm:[2,2,2,2] row_mask:0xf bank_mask:0xf
    v_and_b32_dpp v53, v42, v5 quad_perm:[2,2,2,2] row_mask:0xf bank_mask:0xf
    v_and_b32_dpp v54, v42, v6 quad_perm:[2,2,2,2] row_mask:0xf bank_mask:0xf
    v_and_b32_dpp v55, v42, v7 quad_perm:[2,2,2,2] row_mask:0xf bank_mask:0xf
    v_mfma_f32_16x16x32_bf16 v[36:39], v[56:59], v[108:111], v[36:39]
    v_and_b32_dpp v56, v43, v4 quad_perm:[2,2,2,2] row_mask:0xf bank_mask:0xf
    v_and_b32_dpp v57, v43, v5 quad_perm:[2,2,2,2] row_mask:0xf bank_mask:0xf
    v_and_b32_dpp v58, v43, v6 quad_perm:[2,2,2,2] row_mask:0xf bank_mask:0xf
    v_and_b32_dpp v59, v43, v7 quad_perm:[2,2,2,2] row_mask:0xf bank_mask:0xf
    v_mfma_f32_16x16x32_bf16 v[36:39], v[52:55], v[112:115], v[36:39]
    v_and_b32_dpp v52, v42, v4 quad_perm:[3,3,3,3] row_mask:0xf bank_mask:0xf
    v_and_b32_dpp v53, v42, v5 quad_perm:[3,3,3,3] row_mask:0xf bank_mask:0xf
    v_and_b32_dpp v54, v42, v6 quad_perm:[3,3,3,3] row_mask:0xf bank_mask:0xf
    v_and_b32_dpp v55, v42, v7 quad_perm:[3,3,3,3] row_mask:0xf bank_mask:0xf
    v_mfma_f32_16x16x32_bf16 v[36:39], v[56:59], v[116:119], v[36:39]
    v_and_b32_dpp v56, v43, v4 quad_perm:[3,3,3,3] row_mask:0xf bank_mask:0xf
    v_and_b32_dpp v57, v43, v5 quad_perm:[3,3,3,3] row_mask:0xf bank_mask:0xf
    v_and_b32_dpp v58, v43, v6 quad_perm:[3,3,3,3] row_mask:0xf bank_mask:0xf
    v_and_b32_dpp v59, v43, v7 quad_perm:[3,3,3,3] row_mask:0xf bank_mask:0xf
    v_mfma_f32_16x16x32_bf16 v[36:39], v[52:55], v[120:123], v[36:39]
    s_nop 0
    v_mfma_f32_16x16x32_bf16 v[36:39], v[56:59], v[124:127], v[36:39]
    s_nop 7
    v_permlane32_swap_b32 v36, v38
    v_permlane32_swap_b32 v37, v39
    s_nop 0
    v_add_f32_dpp v36, v38, v36 row_ror:8 row_mask:0xf bank_mask:0xf
    v_add_f32_dpp v37, v39, v37 row_ror:8 row_mask:0xf bank_mask:0xf
    v_mov_b32 v38, s42
    s_mov_b32 exec_lo, 0xff00ff
    s_mov_b32 exec_hi, 0xff00ff
    buffer_store_dwordx4 v[36:39], v19, s[16:19], s71 offen sc1
    s_mov_b64 exec, -1
L_MLWAIT:
    s_cmp_eq_u32 s3, 7
    s_cbranch_scc0 L_NOPF
    s_lshl_b32 s45, s38, 7
    s_add_u32 s45, s45, 0x1f000
    s_lshl_b32 s46, s42, 1
    s_mov_b32 s68, 0
L_PFT:
    s_load_dword s8, s[40:41], s45 glc
    s_add_u32 s68, s68, 1
    s_cmp_gt_u32 s68, 262144
    s_cbranch_scc1 L_END
    s_waitcnt lgkmcnt(0)
    s_xor_b32 s9, s8, s46
    s_cmp_lt_u32 s9, 2
    s_cbranch_scc1 L_PFD
    s_sleep 8
    s_branch L_PFT
L_PFD:
    s_or_b32 s9, s9, 2
    v_mov_b32 v1, 0x211b0
    v_mov_b32 v2, s9
    ds_write_b32 v1, v2
L_NOPF:
    v_mov_b32 v3, 0x21180
    s_mov_b32 s68, 0
L_mlw11:
    ds_read_b128 v[216:219], v3
    s_add_u32 s68, s68, 1
    s_cmp_gt_u32 s68, 2097152
    s_cbranch_scc1 L_END
    s_waitcnt lgkmcnt(0)
    v_cmp_eq_u32 vcc, 0, v218
    s_cbranch_vccz L_mlwd12
    s_sleep 1
    s_branch L_mlw11
L_mlwd12:
    s_branch L_PCALC
L_C0ML:
    v_and_b32 v3, 3, v0
    v_lshlrev_b32 v3, 4, v3
    v_add_u32 v3, 0x21140, v3
    s_lshl_b32 s70, s36, 7
    s_add_u32 s70, s70, 0x19000
    s_lshl_b32 s69, s37, 4
    s_add_u32 s69, s69, s70
    s_mov_b32 s68, 0
L_msw13:
    ds_read_b128 v[220:223], v3
    s_add_u32 s68, s68, 1
    s_cmp_gt_u32 s68, 2097152
    s_cbranch_scc1 L_END
    s_waitcnt lgkmcnt(0)
    v_cmp_eq_u32 vcc, 0, v222
    s_cbranch_vccnz L_msw13
    v_max_f32_dpp v216, v220, v220 quad_perm:[1,0,3,2] row_mask:0xf bank_mask:0xf
    v_mov_b32 v218, s42
    v_mov_b32 v219, s42
    v_max_f32_dpp v216, v216, v216 quad_perm:[2,3,0,1] row_mask:0xf bank_mask:0xf
    v_sub_f32 v220, v220, v216
    v_mul_f32 v220, 0x3fb8aa3b, v220
    v_exp_f32 v220, v220
    v_mov_b32 v1, 0
    v_mul_f32 v217, v220, v221
    s_nop 1
    v_add_f32_dpp v217, v217, v217 quad_perm:[1,0,3,2] row_mask:0xf bank_mask:0xf
    s_nop 1
    v_add_f32_dpp v217, v217, v217 quad_perm:[2,3,0,1] row_mask:0xf bank_mask:0xf
    s_mov_b64 exec, 1
    buffer_store_dwordx4 v[216:219], v1, s[16:19], s69 offen sc1
    s_mov_b64 exec, -1
    s_add_u32 s74, s40, s70
    s_addc_u32 s75, s41, 0
    s_mov_b32 s68, 0
L_MLW:
    s_sleep 4
    s_load_dwordx16 s[4:19], s[74:75], 0 glc
    s_load_dwordx16 s[20:35], s[74:75], 64 glc
    s_add_u32 s68, s68, 1
    s_cmp_gt_u32 s68, 262144
    s_cbranch_scc1 L_END
    s_waitcnt lgkmcnt(0)
    s_xor_b32 s45, s6, s42
    s_xor_b32 s46, s10, s42
    s_or_b32 s45, s45, s46
    s_xor_b32 s46, s14, s42
    s_or_b32 s45, s45, s46
    s_xor_b32 s46, s18, s42
    s_or_b32 s45, s45, s46
    s_xor_b32 s46, s22, s42
    s_or_b32 s45, s45, s46
    s_xor_b32 s46, s26, s42
    s_or_b32 s45, s45, s46
    s_xor_b32 s46, s30, s42
    s_or_b32 s45, s45, s46
    s_xor_b32 s46, s34, s42
    s_or_b32 s45, s45, s46
    s_cbranch_scc1 L_MLW
    v_mov_b32 v216, s4
    v_max_f32 v216, s8, v216
    v_max_f32 v216, s12, v216
    v_max_f32 v216, s16, v216
    v_max_f32 v216, s20, v216
    v_max_f32 v216, s24, v216
    v_max_f32 v216, s28, v216
    v_max_f32 v216, s32, v216
    v_sub_f32 v220, s4, v216
    v_sub_f32 v221, s8, v216
    v_sub_f32 v222, s12, v216
    v_sub_f32 v223, s16, v216
    v_sub_f32 v224, s20, v216
    v_sub_f32 v225, s24, v216
    v_sub_f32 v226, s28, v216
    v_sub_f32 v227, s32, v216
    v_mul_f32 v220, 0x3fb8aa3b, v220
    v_mul_f32 v221, 0x3fb8aa3b, v221
    v_mul_f32 v222, 0x3fb8aa3b, v222
    v_mul_f32 v223, 0x3fb8aa3b, v223
    v_mul_f32 v224, 0x3fb8aa3b, v224
    v_mul_f32 v225, 0x3fb8aa3b, v225
    v_mul_f32 v226, 0x3fb8aa3b, v226
    v_mul_f32 v227, 0x3fb8aa3b, v227
    v_exp_f32 v220, v220
    v_exp_f32 v221, v221
    v_exp_f32 v222, v222
    v_exp_f32 v223, v223
    v_exp_f32 v224, v224
    v_exp_f32 v225, v225
    v_exp_f32 v226, v226
    v_exp_f32 v227, v227
    v_mul_f32 v210, s5, v220
    v_fmac_f32 v210, s9, v221
    v_fmac_f32 v210, s13, v222
    v_fmac_f32 v210, s17, v223
    v_fmac_f32 v210, s21, v224
    v_fmac_f32 v210, s25, v225
    v_fmac_f32 v210, s29, v226
    v_fmac_f32 v210, s33, v227
    v_rcp_f32 v211, v210
    v_mov_b32 v3, 0x21180
    v_mov_b32 v218, 1
    v_fma_f32 v210, -v210, v211, 1.0
    v_fma_f32 v217, v210, v211, v211
    s_mov_b64 exec, 1
    ds_write_b128 v3, v[216:219]
    s_mov_b64 exec, -1
L_PCALC:
    v_sub_f32 v210, v208, v216
    v_sub_f32 v211, v209, v216
    v_mul_f32 v210, 0x3fb8aa3b, v210
    v_mul_f32 v211, 0x3fb8aa3b, v211
    v_exp_f32 v210, v210
    v_exp_f32 v211, v211
    v_mul_f32 v210, v210, v217
    v_mul_f32 v211, v211, v217
    v_cvt_pk_bf16_f32 v210, v210, v210
    v_cvt_pk_bf16_f32 v211, v211, v211
    ds_write_b64 v27, v[210:211]
    s_mov_b32 s16, s40
    s_mov_b32 s17, s41
    s_mov_b32 s18, 0x300000
    s_mov_b32 s19, 0x20000
    s_cmp_eq_u32 s3, 4
    s_cbranch_scc1 L_C0B1
    s_waitcnt lgkmcnt(0)
    s_barrier
    s_cmp_eq_u32 s3, 5
    s_cbranch_scc1 L_C1B1
    s_branch L_C23B1
L_C0B1:
    s_mov_b32 s20, s50
    s_mov_b32 s21, s51
    s_mov_b32 s22, 0x400000
    s_mov_b32 s23, 0x20000
    v_bfe_u32 v1, v0, 3, 1
    v_lshlrev_b32 v1, 16, v1
    v_bfe_u32 v2, v0, 4, 1
    v_lshl_add_u32 v1, v2, 12, v1
    v_lshrrev_b32 v2, 5, v0
    v_lshl_add_u32 v1, v2, 11, v1
    v_and_b32 v2, 7, v0
    v_lshl_add_u32 v62, v2, 4, v1
    s_lshl_b32 s69, s36, 17
    s_lshl_b32 s45, s37, 7
    s_add_u32 s69, s69, s45
    s_waitcnt lgkmcnt(0)
    s_barrier
    v_mov_b32 v15, 0x211b0
    ds_read_b32 v15, v15
    buffer_load_dwordx4 v[64:67], v62, s[20:23], s69 offen offset:0 nt
    buffer_load_dwordx4 v[68:71], v62, s[20:23], s69 offen offset:1024 nt
    s_add_u32 s69, s69, 8192
    buffer_load_dwordx4 v[72:75], v62, s[20:23], s69 offen offset:0 nt
    buffer_load_dwordx4 v[76:79], v62, s[20:23], s69 offen offset:1024 nt
    s_add_u32 s69, s69, 8192
    buffer_load_dwordx4 v[80:83], v62, s[20:23], s69 offen offset:0 nt
    buffer_load_dwordx4 v[84:87], v62, s[20:23], s69 offen offset:1024 nt
    s_add_u32 s69, s69, 8192
    buffer_load_dwordx4 v[88:91], v62, s[20:23], s69 offen offset:0 nt
    buffer_load_dwordx4 v[92:95], v62, s[20:23], s69 offen offset:1024 nt
    s_add_u32 s69, s69, 8192
    buffer_load_dwordx4 v[96:99], v62, s[20:23], s69 offen offset:0 nt
    buffer_load_dwordx4 v[100:103], v62, s[20:23], s69 offen offset:1024 nt
    s_add_u32 s69, s69, 8192
    buffer_load_dwordx4 v[104:107], v62, s[20:23], s69 offen offset:0 nt
    buffer_load_dwordx4 v[108:111], v62, s[20:23], s69 offen offset:1024 nt
    s_add_u32 s69, s69, 8192
    buffer_load_dwordx4 v[112:115], v62, s[20:23], s69 offen offset:0 nt
    buffer_load_dwordx4 v[116:119], v62, s[20:23], s69 offen offset:1024 nt
    s_add_u32 s69, s69, 8192
    buffer_load_dwordx4 v[120:123], v62, s[20:23], s69 offen offset:0 nt
    buffer_load_dwordx4 v[124:127], v62, s[20:23], s69 offen offset:1024 nt
    v_lshrrev_b32 v3, 1, v60
    v_add_u32 v3, 0x20800, v3
    s_waitcnt lgkmcnt(0)
    v_readfirstlane_b32 s52, v15
    s_nop 0
    s_and_b32 s52, s52, 1
    s_lshr_b32 s53, s38, 2
    s_xor_b32 s53, s53, s52
    s_lshl_b32 s53, s53, 13
    s_lshl_b32 s70, s36, 14
    s_add_u32 s70, s70, 0x60000
    s_add_u32 s70, s70, s53
    s_lshl_b32 s69, s37, 10
    s_add_u32 s69, s69, s70
    s_add_u32 s71, s70, 4096
    s_lshl_b32 s72, s37, 5
    s_add_u32 s72, s72, s36
    s_lshl_b32 s72, s72, 9
    s_add_u32 s72, s72, 0x200000
    v_mov_b32 v22, s42
    v_mov_b32 v14, 0x211a0
    v_bfe_u32 v1, v0, 3, 1
    v_xor_b32 v1, s52, v1
    v_lshl_add_u32 v13, v1, 13, v19
    s_lshl_b32 s72, s37, 1
    s_lshr_b32 s45, s36, 4
    s_add_u32 s72, s72, s45
    s_lshl_b32 s72, s72, 14
    s_and_b32 s45, s36, 15
    s_lshl_b32 s45, s45, 9
    s_add_u32 s72, s72, s45
    s_add_u32 s72, s72, 0x140000
    s_sub_u32 s45, s39, 8
    s_cmp_lt_u32 s39, 8
    s_cselect_b32 s46, s39, s45
    s_and_b32 s4, s46, 3
    s_lshr_b32 s46, s46, 2
    s_mul_i32 s43, s38, 11
    s_add_u32 s43, s43, 1
    s_lshr_b32 s43, s43, 1
    s_min_u32 s43, s43, 38
    s_add_u32 s43, s43, s46
    s_cmp_lt_u32 s45, 8
    s_cselect_b32 s43, 255, s43
    s_mov_b32 s45, 0x15
    s_bitcmp1_b32 s45, s38
    s_cselect_b32 s45, 6, 5
    s_cmp_lt_u32 s46, s45
    s_cselect_b32 s43, s43, 255
    s_mov_b32 s24, s58
    s_mov_b32 s25, s59
    s_mov_b32 s26, 0x158000
    s_mov_b32 s27, 0x20000
    v_lshrrev_b32 v1, 3, v0
    v_mul_u32_u24 v1, 44032, v1
    v_and_b32 v2, 3, v0
    v_lshl_add_u32 v1, v2, 4, v1
    s_mul_i32 s45, s4, 352256
    s_min_u32 s46, s43, 42
    s_lshl_b32 s46, s46, 6
    s_add_u32 s45, s45, s46
    v_add_u32 v1, s45, v1
    s_mov_b32 s74, 0xf0f0f0f0
    s_mov_b32 s75, 0xf0f0f0f0
    s_mov_b32 s6, 2752*2
    s_mov_b32 s7, 0
    v_mov_b32 v8, s54
    v_mov_b32 v9, s55
    v_mov_b32 v2, s56
    v_mov_b32 v11, s57
    v_cndmask_b32 v8, v8, v2, s[74:75]
    v_cndmask_b32 v9, v9, v11, s[74:75]
    v_add_co_u32 v8, vcc, v8, v1
    s_nop 1
    v_addc_co_u32 v9, vcc, 0, v9, vcc
    v_bfe_u32 v1, v0, 4, 1
    v_lshlrev_b32 v10, 12, v1
    v_lshrrev_b32 v1, 5, v0
    v_lshl_add_u32 v10, v1, 11, v10
    v_and_b32 v1, 15, v0
    v_lshl_add_u32 v10, v1, 4, v10
    s_lshl_b32 s8, s43, 15
    s_lshl_b32 s45, s4, 8
    s_add_u32 s8, s8, s45
    s_lshr_b32 s10, s43, 2
    s_lshl_b32 s10, s10, 14
    s_and_b32 s45, s43, 3
    s_lshl_b32 s45, s45, 11
    s_add_u32 s10, s10, s45
    s_add_u32 s10, s10, 0x110000
    s_add_u32 s10, s10, s53
    s_lshl_b32 s45, s4, 9
    s_add_u32 s9, s10, s45
    s_lshr_b32 s11, s43, 2
    s_lshl_b32 s11, s11, 14
    s_and_b32 s45, s43, 3
    s_lshl_b32 s45, s45, 11
    s_add_u32 s11, s11, s45
    s_lshl_b32 s45, s4, 9
    s_add_u32 s11, s11, s45
    s_add_u32 s11, s11, 0xe0000
    v_and_b32 v17, 31, v0
    v_lshlrev_b32 v17, 4, v17
    v_lshrrev_b32 v1, 5, v0
    v_xor_b32 v1, s52, v1
    v_lshl_add_u32 v17, v1, 13, v17
    s_lshr_b32 s46, s38, 1
    s_lshl_b32 s46, s46, 14
    s_and_b32 s45, s38, 1
    s_lshl_b32 s45, s45, 12
    s_add_u32 s46, s46, s45
    s_add_u32 s46, s46, 0x180000
    s_add_u32 s46, s46, s53
    s_add_u32 s45, s4, 0
    s_and_b32 s45, s45, 3
    s_lshl_b32 s45, s45, 10
    s_add_u32 s12, s45, s46
    s_add_u32 s45, s4, 1
    s_and_b32 s45, s45, 3
    s_lshl_b32 s45, s45, 10
    s_add_u32 s13, s45, s46
    s_add_u32 s45, s4, 2
    s_and_b32 s45, s45, 3
    s_lshl_b32 s45, s45, 10
    s_add_u32 s14, s45, s46
    s_add_u32 s45, s4, 3
    s_and_b32 s45, s45, 3
    s_lshl_b32 s45, s45, 10
    s_add_u32 s15, s45, s46
    v_lshrrev_b32 v1, 5, v0
    v_lshlrev_b32 v11, 9, v1
    v_bfe_u32 v1, v0, 1, 1
    v_lshl_add_u32 v11, v1, 7, v11
    v_and_b32 v1, 1, v0
    v_lshl_add_u32 v11, v1, 8, v11
    v_bfe_u32 v1, v0, 2, 3
    v_lshl_add_u32 v11, v1, 4, v11
    v_bfe_u32 v1, v0, 3, 1
    v_lshlrev_b32 v1, 9, v1
    v_add_u32 v12, v19, v1
    s_branch L_TAIL0
    .p2align 12
L_TAIL0:
    s_barrier
    ds_read_b64 v[24:25], v3 offset:0
    ds_read_b64 v[26:27], v3 offset:512
    ds_read_b64 v[28:29], v3 offset:1024
    ds_read_b64 v[30:31], v3 offset:1536
    s_waitcnt lgkmcnt(2)
    v_pk_add_f32 v[24:25], v[24:25], v[26:27]
    s_waitcnt lgkmcnt(0)
    v_pk_add_f32 v[28:29], v[28:29], v[30:31]
    v_pk_add_f32 v[20:21], v[24:25], v[28:29]
    s_cmp_eq_u32 s73, 1
    s_cbranch_scc0 L_far14
    buffer_store_dwordx4 v[20:23], v60, s[16:19], s69 offen
    s_branch L_pb15
L_far14:
    buffer_store_dwordx4 v[20:23], v60, s[16:19], s69 offen sc1
L_pb15:
    s_mov_b32 s68, 0
L_xa16:
    buffer_load_dwordx4 v[128:131], v60, s[16:19], s70 offen offset:0 sc1
    buffer_load_dwordx4 v[132:135], v60, s[16:19], s70 offen offset:1024 sc1
    buffer_load_dwordx4 v[136:139], v60, s[16:19], s70 offen offset:2048 sc1
    buffer_load_dwordx4 v[140:143], v60, s[16:19], s70 offen offset:3072 sc1
    buffer_load_dwordx4 v[144:147], v60, s[16:19], s71 offen offset:0 sc1
    buffer_load_dwordx4 v[148:151], v60, s[16:19], s71 offen offset:1024 sc1
    buffer_load_dwordx4 v[152:155], v60, s[16:19], s71 offen offset:2048 sc1
    buffer_load_dwordx4 v[156:159], v60, s[16:19], s71 offen offset:3072 sc1
    s_add_u32 s68, s68, 1
    s_cmp_gt_u32 s68, 262144
    s_cbranch_scc1 L_END
    s_waitcnt vmcnt(0)
    v_xor_b32 v1, s42, v130
    v_xor_b32 v2, s42, v134
    v_bitop3_b32 v1, v138, s42, v1 bitop3:0xbe
    v_bitop3_b32 v2, v142, s42, v2 bitop3:0xbe
    v_bitop3_b32 v1, v146, s42, v1 bitop3:0xbe
    v_bitop3_b32 v2, v150, s42, v2 bitop3:0xbe
    v_bitop3_b32 v1, v154, s42, v1 bitop3:0xbe
    v_bitop3_b32 v2, v158, s42, v2 bitop3:0xbe
    v_or_b32 v1, v1, v2
    v_cmp_ne_u32 vcc, 0, v1
    s_cbranch_vccnz L_xa16
L_xax18:
    v_pk_add_f32 v[128:129], v[128:129], v[132:133]
    v_pk_add_f32 v[136:137], v[136:137], v[140:141]
    v_pk_add_f32 v[144:145], v[144:145], v[148:149]
    v_pk_add_f32 v[152:153], v[152:153], v[156:157]
    v_pk_add_f32 v[128:129], v[128:129], v[136:137]
    v_pk_add_f32 v[144:145], v[144:145], v[152:153]
    v_pk_add_f32 v[128:129], v[128:129], v[144:145]
    v_cvt_pk_bf16_f32 v40, v128, v128
    v_cvt_pk_bf16_f32 v41, v129, v129
L_xaj17:
    v_mov_b32 v42, v40
    v_mov_b32 v43, v41
    s_nop 0
    v_mov_b32_dpp v42, v40 row_shl:4 row_mask:0xf bank_mask:0x5
    v_mov_b32_dpp v43, v41 row_shl:4 row_mask:0xf bank_mask:0x5
    v_mov_b32_dpp v40, v40 row_shr:4 row_mask:0xf bank_mask:0xa
    v_mov_b32_dpp v41, v41 row_shr:4 row_mask:0xf bank_mask:0xa
    s_nop 0
    v_and_b32_dpp v52, v40, v4 quad_perm:[0,0,0,0] row_mask:0xf bank_mask:0xf
    v_and_b32_dpp v53, v40, v5 quad_perm:[0,0,0,0] row_mask:0xf bank_mask:0xf
    v_and_b32_dpp v54, v40, v6 quad_perm:[0,0,0,0] row_mask:0xf bank_mask:0xf
    v_and_b32_dpp v55, v40, v7 quad_perm:[0,0,0,0] row_mask:0xf bank_mask:0xf
    v_and_b32_dpp v56, v41, v4 quad_perm:[0,0,0,0] row_mask:0xf bank_mask:0xf
    v_and_b32_dpp v57, v41, v5 quad_perm:[0,0,0,0] row_mask:0xf bank_mask:0xf
    v_and_b32_dpp v58, v41, v6 quad_perm:[0,0,0,0] row_mask:0xf bank_mask:0xf
    v_and_b32_dpp v59, v41, v7 quad_perm:[0,0,0,0] row_mask:0xf bank_mask:0xf
    v_mfma_f32_16x16x32_bf16 v[36:39], v[52:55], v[64:67], 0
    v_and_b32_dpp v52, v40, v4 quad_perm:[1,1,1,1] row_mask:0xf bank_mask:0xf
    v_and_b32_dpp v53, v40, v5 quad_perm:[1,1,1,1] row_mask:0xf bank_mask:0xf
    v_and_b32_dpp v54, v40, v6 quad_perm:[1,1,1,1] row_mask:0xf bank_mask:0xf
    v_and_b32_dpp v55, v40, v7 quad_perm:[1,1,1,1] row_mask:0xf bank_mask:0xf
    v_mfma_f32_16x16x32_bf16 v[36:39], v[56:59], v[68:71], v[36:39]
    v_and_b32_dpp v56, v41, v4 quad_perm:[1,1,1,1] row_mask:0xf bank_mask:0xf
    v_and_b32_dpp v57, v41, v5 quad_perm:[1,1,1,1] row_mask:0xf bank_mask:0xf
    v_and_b32_dpp v58, v41, v6 quad_perm:[1,1,1,1] row_mask:0xf bank_mask:0xf
    v_and_b32_dpp v59, v41, v7 quad_perm:[1,1,1,1] row_mask:0xf bank_mask:0xf
    v_mfma_f32_16x16x32_bf16 v[36:39], v[52:55], v[72:75], v[36:39]
    v_and_b32_dpp v52, v40, v4 quad_perm:[2,2,2,2] row_mask:0xf bank_mask:0xf
    v_and_b32_dpp v53, v40, v5 quad_perm:[2,2,2,2] row_mask:0xf bank_mask:0xf
    v_and_b32_dpp v54, v40, v6 quad_perm:[2,2,2,2] row_mask:0xf bank_mask:0xf
    v_and_b32_dpp v55, v40, v7 quad_perm:[2,2,2,2] row_mask:0xf bank_mask:0xf
    v_mfma_f32_16x16x32_bf16 v[36:39], v[56:59], v[76:79], v[36:39]
    v_and_b32_dpp v56, v41, v4 quad_perm:[2,2,2,2] row_mask:0xf bank_mask:0xf
    v_and_b32_dpp v57, v41, v5 quad_perm:[2,2,2,2] row_mask:0xf bank_mask:0xf
    v_and_b32_dpp v58, v41, v6 quad_perm:[2,2,2,2] row_mask:0xf bank_mask:0xf
    v_and_b32_dpp v59, v41, v7 quad_perm:[2,2,2,2] row_mask:0xf bank_mask:0xf
    v_mfma_f32_16x16x32_bf16 v[36:39], v[52:55], v[80:83], v[36:39]
    v_and_b32_dpp v52, v40, v4 quad_perm:[3,3,3,3] row_mask:0xf bank_mask:0xf
    v_and_b32_dpp v53, v40, v5 quad_perm:[3,3,3,3] row_mask:0xf bank_mask:0xf
    v_and_b32_dpp v54, v40, v6 quad_perm:[3,3,3,3] row_mask:0xf bank_mask:0xf
    v_and_b32_dpp v55, v40, v7 quad_perm:[3,3,3,3] row_mask:0xf bank_mask:0xf
    v_mfma_f32_16x16x32_bf16 v[36:39], v[56:59], v[84:87], v[36:39]
    v_and_b32_dpp v56, v41, v4 quad_perm:[3,3,3,3] row_mask:0xf bank_mask:0xf
    v_and_b32_dpp v57, v41, v5 quad_perm:[3,3,3,3] row_mask:0xf bank_mask:0xf
    v_and_b32_dpp v58, v41, v6 quad_perm:[3,3,3,3] row_mask:0xf bank_mask:0xf
    v_and_b32_dpp v59, v41, v7 quad_perm:[3,3,3,3] row_mask:0xf bank_mask:0xf
    v_mfma_f32_16x16x32_bf16 v[36:39], v[52:55], v[88:91], v[36:39]
    v_and_b32_dpp v52, v42, v4 quad_perm:[0,0,0,0] row_mask:0xf bank_mask:0xf
    v_and_b32_dpp v53, v42, v5 quad_perm:[0,0,0,0] row_mask:0xf bank_mask:0xf
    v_and_b32_dpp v54, v42, v6 quad_perm:[0,0,0,0] row_mask:0xf bank_mask:0xf
    v_and_b32_dpp v55, v42, v7 quad_perm:[0,0,0,0] row_mask:0xf bank_mask:0xf
    v_mfma_f32_16x16x32_bf16 v[36:39], v[56:59], v[92:95], v[36:39]
    v_and_b32_dpp v56, v43, v4 quad_perm:[0,0,0,0] row_mask:0xf bank_mask:0xf
    v_and_b32_dpp v57, v43, v5 quad_perm:[0,0,0,0] row_mask:0xf bank_mask:0xf
    v_and_b32_dpp v58, v43, v6 quad_perm:[0,0,0,0] row_mask:0xf bank_mask:0xf
    v_and_b32_dpp v59, v43, v7 quad_perm:[0,0,0,0] row_mask:0xf bank_mask:0xf
    v_mfma_f32_16x16x32_bf16 v[36:39], v[52:55], v[96:99], v[36:39]
    v_and_b32_dpp v52, v42, v4 quad_perm:[1,1,1,1] row_mask:0xf bank_mask:0xf
    v_and_b32_dpp v53, v42, v5 quad_perm:[1,1,1,1] row_mask:0xf bank_mask:0xf
    v_and_b32_dpp v54, v42, v6 quad_perm:[1,1,1,1] row_mask:0xf bank_mask:0xf
    v_and_b32_dpp v55, v42, v7 quad_perm:[1,1,1,1] row_mask:0xf bank_mask:0xf
    v_mfma_f32_16x16x32_bf16 v[36:39], v[56:59], v[100:103], v[36:39]
    v_and_b32_dpp v56, v43, v4 quad_perm:[1,1,1,1] row_mask:0xf bank_mask:0xf
    v_and_b32_dpp v57, v43, v5 quad_perm:[1,1,1,1] row_mask:0xf bank_mask:0xf
    v_and_b32_dpp v58, v43, v6 quad_perm:[1,1,1,1] row_mask:0xf bank_mask:0xf
    v_and_b32_dpp v59, v43, v7 quad_perm:[1,1,1,1] row_mask:0xf bank_mask:0xf
    v_mfma_f32_16x16x32_bf16 v[36:39], v[52:55], v[104:107], v[36:39]
    v_and_b32_dpp v52, v42, v4 quad_perm:[2,2,2,2] row_mask:0xf bank_mask:0xf
    v_and_b32_dpp v53, v42, v5 quad_perm:[2,2,2,2] row_mask:0xf bank_mask:0xf
    v_and_b32_dpp v54, v42, v6 quad_perm:[2,2,2,2] row_mask:0xf bank_mask:0xf
    v_and_b32_dpp v55, v42, v7 quad_perm:[2,2,2,2] row_mask:0xf bank_mask:0xf
    v_mfma_f32_16x16x32_bf16 v[36:39], v[56:59], v[108:111], v[36:39]
    v_and_b32_dpp v56, v43, v4 quad_perm:[2,2,2,2] row_mask:0xf bank_mask:0xf
    v_and_b32_dpp v57, v43, v5 quad_perm:[2,2,2,2] row_mask:0xf bank_mask:0xf
    v_and_b32_dpp v58, v43, v6 quad_perm:[2,2,2,2] row_mask:0xf bank_mask:0xf
    v_and_b32_dpp v59, v43, v7 quad_perm:[2,2,2,2] row_mask:0xf bank_mask:0xf
    v_mfma_f32_16x16x32_bf16 v[36:39], v[52:55], v[112:115], v[36:39]
    v_and_b32_dpp v52, v42, v4 quad_perm:[3,3,3,3] row_mask:0xf bank_mask:0xf
    v_and_b32_dpp v53, v42, v5 quad_perm:[3,3,3,3] row_mask:0xf bank_mask:0xf
    v_and_b32_dpp v54, v42, v6 quad_perm:[3,3,3,3] row_mask:0xf bank_mask:0xf
    v_and_b32_dpp v55, v42, v7 quad_perm:[3,3,3,3] row_mask:0xf bank_mask:0xf
    v_mfma_f32_16x16x32_bf16 v[36:39], v[56:59], v[116:119], v[36:39]
    v_and_b32_dpp v56, v43, v4 quad_perm:[3,3,3,3] row_mask:0xf bank_mask:0xf
    v_and_b32_dpp v57, v43, v5 quad_perm:[3,3,3,3] row_mask:0xf bank_mask:0xf
    v_and_b32_dpp v58, v43, v6 quad_perm:[3,3,3,3] row_mask:0xf bank_mask:0xf
    v_and_b32_dpp v59, v43, v7 quad_perm:[3,3,3,3] row_mask:0xf bank_mask:0xf
    v_mfma_f32_16x16x32_bf16 v[36:39], v[52:55], v[120:123], v[36:39]
    s_nop 0
    v_mfma_f32_16x16x32_bf16 v[36:39], v[56:59], v[124:127], v[36:39]
    s_nop 7
    v_permlane32_swap_b32 v36, v38
    v_permlane32_swap_b32 v37, v39
    s_nop 0
    v_add_f32_dpp v36, v38, v36 row_ror:8 row_mask:0xf bank_mask:0xf
    v_add_f32_dpp v37, v39, v37 row_ror:8 row_mask:0xf bank_mask:0xf
    v_mov_b32 v38, s42
    v_mov_b32_dpp v36, v36 row_ror:8 row_mask:0xf bank_mask:0xc
    v_mov_b32_dpp v37, v37 row_ror:8 row_mask:0xf bank_mask:0xc
    buffer_store_dwordx4 v[36:39], v13, s[16:19], s72 offen sc1
    ds_write_b32 v14, v14
    s_cmp_lt_u32 s43, 43
    s_cbranch_scc0 L_END
    global_load_dwordx4 v[128:131], v[8:9], off offset:0 nt
    global_load_dwordx4 v[132:135], v[8:9], off offset:2752 nt
    v_lshl_add_u64 v[8:9], v[8:9], 0, s[6:7]
    global_load_dwordx4 v[136:139], v[8:9], off offset:0 nt
    global_load_dwordx4 v[140:143], v[8:9], off offset:2752 nt
    v_lshl_add_u64 v[8:9], v[8:9], 0, s[6:7]
    global_load_dwordx4 v[144:147], v[8:9], off offset:0 nt
    global_load_dwordx4 v[148:151], v[8:9], off offset:2752 nt
    v_lshl_add_u64 v[8:9], v[8:9], 0, s[6:7]
    global_load_dwordx4 v[152:155], v[8:9], off offset:0 nt
    global_load_dwordx4 v[156:159], v[8:9], off offset:2752 nt
    v_lshl_add_u64 v[8:9], v[8:9], 0, s[6:7]
    global_load_dwordx4 v[160:163], v[8:9], off offset:0 nt
    global_load_dwordx4 v[164:167], v[8:9], off offset:2752 nt
    v_lshl_add_u64 v[8:9], v[8:9], 0, s[6:7]
    global_load_dwordx4 v[168:171], v[8:9], off offset:0 nt
    global_load_dwordx4 v[172:175], v[8:9], off offset:2752 nt
    v_lshl_add_u64 v[8:9], v[8:9], 0, s[6:7]
    global_load_dwordx4 v[176:179], v[8:9], off offset:0 nt
    global_load_dwordx4 v[180:183], v[8:9], off offset:2752 nt
    v_lshl_add_u64 v[8:9], v[8:9], 0, s[6:7]
    global_load_dwordx4 v[184:187], v[8:9], off offset:0 nt
    global_load_dwordx4 v[188:191], v[8:9], off offset:2752 nt
    buffer_load_dwordx4 v[192:195], v10, s[24:27], s8 offen offset:0 nt
    buffer_load_dwordx4 v[196:199], v10, s[24:27], s8 offen offset:1024 nt
    s_add_u32 s8, s8, 8192
    buffer_load_dwordx4 v[200:203], v10, s[24:27], s8 offen offset:0 nt
    buffer_load_dwordx4 v[204:207], v10, s[24:27], s8 offen offset:1024 nt
    s_add_u32 s8, s8, 8192
    buffer_load_dwordx4 v[208:211], v10, s[24:27], s8 offen offset:0 nt
    buffer_load_dwordx4 v[212:215], v10, s[24:27], s8 offen offset:1024 nt
    s_add_u32 s8, s8, 8192
    buffer_load_dwordx4 v[216:219], v10, s[24:27], s8 offen offset:0 nt
    buffer_load_dwordx4 v[220:223], v10, s[24:27], s8 offen offset:1024 nt
    s_waitcnt vmcnt(0)
    s_mov_b32 s68, 0
L_xc19:
    buffer_load_dwordx4 v[64:67], v11, s[16:19], s12 offen sc1
    buffer_load_dwordx4 v[68:71], v11, s[16:19], s13 offen sc1
    buffer_load_dwordx4 v[72:75], v11, s[16:19], s14 offen sc1
    buffer_load_dwordx4 v[76:79], v11, s[16:19], s15 offen sc1
    s_add_u32 s68, s68, 1
    s_cmp_gt_u32 s68, 262144
    s_cbranch_scc1 L_END
    s_waitcnt vmcnt(0)
    v_xor_b32 v1, s42, v67
    v_xor_b32 v2, s42, v71
    v_bitop3_b32 v1, v75, s42, v1 bitop3:0xbe
    v_bitop3_b32 v2, v79, s42, v2 bitop3:0xbe
    v_or_b32 v1, v1, v2
    v_cmp_ne_u32 vcc, 0, v1
    s_cbranch_vccnz L_xc19
L_xcx21:
    v_lshlrev_b32 v88, 16, v64
    v_and_b32 v89, 0xffff0000, v64
    v_lshlrev_b32 v90, 16, v68
    v_and_b32 v91, 0xffff0000, v68
    v_lshlrev_b32 v92, 16, v72
    v_and_b32 v93, 0xffff0000, v72
    v_lshlrev_b32 v94, 16, v76
    v_and_b32 v95, 0xffff0000, v76
L_xcj20:
    v_readfirstlane_b32 s45, v88
    s_nop 1
    v_subrev_f32 v96, s45, v88
    v_subrev_f32 v97, s45, v89
    v_subrev_f32 v98, s45, v90
    v_subrev_f32 v99, s45, v91
    v_subrev_f32 v100, s45, v92
    v_subrev_f32 v101, s45, v93
    v_subrev_f32 v102, s45, v94
    v_subrev_f32 v103, s45, v95
    v_pk_add_f32 v[20:21], v[96:97], v[98:99]
    v_pk_add_f32 v[22:23], v[100:101], v[102:103]
    v_pk_mul_f32 v[28:29], v[96:97], v[96:97]
    v_pk_mul_f32 v[30:31], v[100:101], v[100:101]
    v_pk_add_f32 v[20:21], v[20:21], v[22:23]
    v_pk_fma_f32 v[28:29], v[98:99], v[98:99], v[28:29]
    v_pk_fma_f32 v[30:31], v[102:103], v[102:103], v[30:31]
    v_add_f32 v22, v20, v21
    v_pk_add_f32 v[28:29], v[28:29], v[30:31]
    v_add_f32 v23, v28, v29
    v_add_f32_dpp v22, v22, v22 quad_perm:[1,0,3,2] row_mask:0xf bank_mask:0xf
    v_lshlrev_b32 v24, 16, v65
    v_add_f32_dpp v23, v23, v23 quad_perm:[1,0,3,2] row_mask:0xf bank_mask:0xf
    v_add_f32_dpp v22, v22, v22 quad_perm:[2,3,0,1] row_mask:0xf bank_mask:0xf
    v_and_b32 v25, 0xffff0000, v65
    v_add_f32_dpp v23, v23, v23 quad_perm:[2,3,0,1] row_mask:0xf bank_mask:0xf
    v_add_f32_dpp v22, v22, v22 row_ror:4 row_mask:0xf bank_mask:0xf
    v_lshlrev_b32 v26, 16, v66
    v_add_f32_dpp v23, v23, v23 row_ror:4 row_mask:0xf bank_mask:0xf
    v_add_f32_dpp v22, v22, v22 row_ror:8 row_mask:0xf bank_mask:0xf
    v_and_b32 v27, 0xffff0000, v66
    v_add_f32_dpp v23, v23, v23 row_ror:8 row_mask:0xf bank_mask:0xf
    s_nop 1
    v_permlane16_swap_b32 v22, v23
    v_add_f32 v22, v22, v23
    v_mov_b32 v23, v22
    s_nop 1
    v_permlane32_swap_b32 v22, v23
    v_add_f32 v22, v22, v23
    v_mul_f32 v22, 0x3b000000, v22
    v_mov_b32 v23, v22
    s_nop 1
    v_permlane16_swap_b32 v22, v23
    v_fma_f32 v23, -v22, v22, v23
    v_add_f32 v22, s45, v22
    v_max_f32 v23, 0, v23
    v_cvt_pk_bf16_f32 v22, v22, v23
    v_and_b32 v23, 0xffff0000, v22
    v_lshlrev_b32 v22, 16, v22
    v_add_f32 v23, 0x3727c5ac, v23
    v_sub_f32 v20, v88, v22
    v_sub_f32 v21, v89, v22
    v_cvt_pk_bf16_f32 v23, v23, v23
    v_cvt_pk_bf16_f32 v20, v20, v21
    v_and_b32 v23, 0xffff0000, v23
    v_sqrt_f32 v23, v23
    v_lshlrev_b32 v88, 16, v20
    v_and_b32 v89, 0xffff0000, v20
    v_cvt_pk_bf16_f32 v23, v23, v23
    v_and_b32 v23, 0xffff0000, v23
    v_rcp_f32 v22, v23
    s_nop 0
    v_mul_f32 v20, v88, v22
    v_mul_f32 v21, v89, v22
    v_fma_f32 v88, -v20, v23, v88
    v_fma_f32 v89, -v21, v23, v89
    v_fma_f32 v20, v88, v22, v20
    v_fma_f32 v21, v89, v22, v21
    v_cvt_pk_bf16_f32 v20, v20, v21
    v_lshlrev_b32 v88, 16, v20
    v_and_b32 v89, 0xffff0000, v20
    v_mul_f32 v88, v88, v24
    v_mul_f32 v89, v89, v25
    v_cvt_pk_bf16_f32 v20, v88, v89
    v_lshlrev_b32 v88, 16, v20
    v_and_b32 v89, 0xffff0000, v20
    v_add_f32 v88, v88, v26
    v_add_f32 v89, v89, v27
    v_cvt_pk_bf16_f32 v40, v88, v88
    v_cvt_pk_bf16_f32 v41, v89, v89
    v_mov_b32 v42, v40
    v_mov_b32 v43, v41
    s_nop 0
    v_mov_b32_dpp v42, v40 row_shl:4 row_mask:0xf bank_mask:0x5
    v_mov_b32_dpp v43, v41 row_shl:4 row_mask:0xf bank_mask:0x5
    v_mov_b32_dpp v40, v40 row_shr:4 row_mask:0xf bank_mask:0xa
    v_mov_b32_dpp v41, v41 row_shr:4 row_mask:0xf bank_mask:0xa
    s_nop 0
    v_and_b32_dpp v52, v40, v4 quad_perm:[0,0,0,0] row_mask:0xf bank_mask:0xf
    v_and_b32_dpp v53, v40, v5 quad_perm:[0,0,0,0] row_mask:0xf bank_mask:0xf
    v_and_b32_dpp v54, v40, v6 quad_perm:[0,0,0,0] row_mask:0xf bank_mask:0xf
    v_and_b32_dpp v55, v40, v7 quad_perm:[0,0,0,0] row_mask:0xf bank_mask:0xf
    v_and_b32_dpp v56, v41, v4 quad_perm:[0,0,0,0] row_mask:0xf bank_mask:0xf
    v_and_b32_dpp v57, v41, v5 quad_perm:[0,0,0,0] row_mask:0xf bank_mask:0xf
    v_and_b32_dpp v58, v41, v6 quad_perm:[0,0,0,0] row_mask:0xf bank_mask:0xf
    v_and_b32_dpp v59, v41, v7 quad_perm:[0,0,0,0] row_mask:0xf bank_mask:0xf
    v_mfma_f32_16x16x32_bf16 v[36:39], v[52:55], v[128:131], 0
    v_and_b32_dpp v52, v40, v4 quad_perm:[1,1,1,1] row_mask:0xf bank_mask:0xf
    v_and_b32_dpp v53, v40, v5 quad_perm:[1,1,1,1] row_mask:0xf bank_mask:0xf
    v_and_b32_dpp v54, v40, v6 quad_perm:[1,1,1,1] row_mask:0xf bank_mask:0xf
    v_and_b32_dpp v55, v40, v7 quad_perm:[1,1,1,1] row_mask:0xf bank_mask:0xf
    v_mfma_f32_16x16x32_bf16 v[36:39], v[56:59], v[132:135], v[36:39]
    v_and_b32_dpp v56, v41, v4 quad_perm:[1,1,1,1] row_mask:0xf bank_mask:0xf
    v_and_b32_dpp v57, v41, v5 quad_perm:[1,1,1,1] row_mask:0xf bank_mask:0xf
    v_and_b32_dpp v58, v41, v6 quad_perm:[1,1,1,1] row_mask:0xf bank_mask:0xf
    v_and_b32_dpp v59, v41, v7 quad_perm:[1,1,1,1] row_mask:0xf bank_mask:0xf
    v_mfma_f32_16x16x32_bf16 v[36:39], v[52:55], v[136:139], v[36:39]
    v_and_b32_dpp v52, v40, v4 quad_perm:[2,2,2,2] row_mask:0xf bank_mask:0xf
    v_and_b32_dpp v53, v40, v5 quad_perm:[2,2,2,2] row_mask:0xf bank_mask:0xf
    v_and_b32_dpp v54, v40, v6 quad_perm:[2,2,2,2] row_mask:0xf bank_mask:0xf
    v_and_b32_dpp v55, v40, v7 quad_perm:[2,2,2,2] row_mask:0xf bank_mask:0xf
    v_mfma_f32_16x16x32_bf16 v[36:39], v[56:59], v[140:143], v[36:39]
    v_and_b32_dpp v56, v41, v4 quad_perm:[2,2,2,2] row_mask:0xf bank_mask:0xf
    v_and_b32_dpp v57, v41, v5 quad_perm:[2,2,2,2] row_mask:0xf bank_mask:0xf
    v_and_b32_dpp v58, v41, v6 quad_perm:[2,2,2,2] row_mask:0xf bank_mask:0xf
    v_and_b32_dpp v59, v41, v7 quad_perm:[2,2,2,2] row_mask:0xf bank_mask:0xf
    v_mfma_f32_16x16x32_bf16 v[36:39], v[52:55], v[144:147], v[36:39]
    v_and_b32_dpp v52, v40, v4 quad_perm:[3,3,3,3] row_mask:0xf bank_mask:0xf
    v_and_b32_dpp v53, v40, v5 quad_perm:[3,3,3,3] row_mask:0xf bank_mask:0xf
    v_and_b32_dpp v54, v40, v6 quad_perm:[3,3,3,3] row_mask:0xf bank_mask:0xf
    v_and_b32_dpp v55, v40, v7 quad_perm:[3,3,3,3] row_mask:0xf bank_mask:0xf
    v_mfma_f32_16x16x32_bf16 v[36:39], v[56:59], v[148:151], v[36:39]
    v_and_b32_dpp v56, v41, v4 quad_perm:[3,3,3,3] row_mask:0xf bank_mask:0xf
    v_and_b32_dpp v57, v41, v5 quad_perm:[3,3,3,3] row_mask:0xf bank_mask:0xf
    v_and_b32_dpp v58, v41, v6 quad_perm:[3,3,3,3] row_mask:0xf bank_mask:0xf
    v_and_b32_dpp v59, v41, v7 quad_perm:[3,3,3,3] row_mask:0xf bank_mask:0xf
    v_mfma_f32_16x16x32_bf16 v[36:39], v[52:55], v[152:155], v[36:39]
    v_and_b32_dpp v52, v42, v4 quad_perm:[0,0,0,0] row_mask:0xf bank_mask:0xf
    v_and_b32_dpp v53, v42, v5 quad_perm:[0,0,0,0] row_mask:0xf bank_mask:0xf
    v_and_b32_dpp v54, v42, v6 quad_perm:[0,0,0,0] row_mask:0xf bank_mask:0xf
    v_and_b32_dpp v55, v42, v7 quad_perm:[0,0,0,0] row_mask:0xf bank_mask:0xf
    v_mfma_f32_16x16x32_bf16 v[36:39], v[56:59], v[156:159], v[36:39]
    v_and_b32_dpp v56, v43, v4 quad_perm:[0,0,0,0] row_mask:0xf bank_mask:0xf
    v_and_b32_dpp v57, v43, v5 quad_perm:[0,0,0,0] row_mask:0xf bank_mask:0xf
    v_and_b32_dpp v58, v43, v6 quad_perm:[0,0,0,0] row_mask:0xf bank_mask:0xf
    v_and_b32_dpp v59, v43, v7 quad_perm:[0,0,0,0] row_mask:0xf bank_mask:0xf
    v_mfma_f32_16x16x32_bf16 v[36:39], v[52:55], v[160:163], v[36:39]
    v_and_b32_dpp v52, v42, v4 quad_perm:[1,1,1,1] row_mask:0xf bank_mask:0xf
    v_and_b32_dpp v53, v42, v5 quad_perm:[1,1,1,1] row_mask:0xf bank_mask:0xf
    v_and_b32_dpp v54, v42, v6 quad_perm:[1,1,1,1] row_mask:0xf bank_mask:0xf
    v_and_b32_dpp v55, v42, v7 quad_perm:[1,1,1,1] row_mask:0xf bank_mask:0xf
    v_mfma_f32_16x16x32_bf16 v[36:39], v[56:59], v[164:167], v[36:39]
    v_and_b32_dpp v56, v43, v4 quad_perm:[1,1,1,1] row_mask:0xf bank_mask:0xf
    v_and_b32_dpp v57, v43, v5 quad_perm:[1,1,1,1] row_mask:0xf bank_mask:0xf
    v_and_b32_dpp v58, v43, v6 quad_perm:[1,1,1,1] row_mask:0xf bank_mask:0xf
    v_and_b32_dpp v59, v43, v7 quad_perm:[1,1,1,1] row_mask:0xf bank_mask:0xf
    v_mfma_f32_16x16x32_bf16 v[36:39], v[52:55], v[168:171], v[36:39]
    v_and_b32_dpp v52, v42, v4 quad_perm:[2,2,2,2] row_mask:0xf bank_mask:0xf
    v_and_b32_dpp v53, v42, v5 quad_perm:[2,2,2,2] row_mask:0xf bank_mask:0xf
    v_and_b32_dpp v54, v42, v6 quad_perm:[2,2,2,2] row_mask:0xf bank_mask:0xf
    v_and_b32_dpp v55, v42, v7 quad_perm:[2,2,2,2] row_mask:0xf bank_mask:0xf
    v_mfma_f32_16x16x32_bf16 v[36:39], v[56:59], v[172:175], v[36:39]
    v_and_b32_dpp v56, v43, v4 quad_perm:[2,2,2,2] row_mask:0xf bank_mask:0xf
    v_and_b32_dpp v57, v43, v5 quad_perm:[2,2,2,2] row_mask:0xf bank_mask:0xf
    v_and_b32_dpp v58, v43, v6 quad_perm:[2,2,2,2] row_mask:0xf bank_mask:0xf
    v_and_b32_dpp v59, v43, v7 quad_perm:[2,2,2,2] row_mask:0xf bank_mask:0xf
    v_mfma_f32_16x16x32_bf16 v[36:39], v[52:55], v[176:179], v[36:39]
    v_and_b32_dpp v52, v42, v4 quad_perm:[3,3,3,3] row_mask:0xf bank_mask:0xf
    v_and_b32_dpp v53, v42, v5 quad_perm:[3,3,3,3] row_mask:0xf bank_mask:0xf
    v_and_b32_dpp v54, v42, v6 quad_perm:[3,3,3,3] row_mask:0xf bank_mask:0xf
    v_and_b32_dpp v55, v42, v7 quad_perm:[3,3,3,3] row_mask:0xf bank_mask:0xf
    v_mfma_f32_16x16x32_bf16 v[36:39], v[56:59], v[180:183], v[36:39]
    v_and_b32_dpp v56, v43, v4 quad_perm:[3,3,3,3] row_mask:0xf bank_mask:0xf
    v_and_b32_dpp v57, v43, v5 quad_perm:[3,3,3,3] row_mask:0xf bank_mask:0xf
    v_and_b32_dpp v58, v43, v6 quad_perm:[3,3,3,3] row_mask:0xf bank_mask:0xf
    v_and_b32_dpp v59, v43, v7 quad_perm:[3,3,3,3] row_mask:0xf bank_mask:0xf
    v_mfma_f32_16x16x32_bf16 v[36:39], v[52:55], v[184:187], v[36:39]
    s_nop 0
    v_mfma_f32_16x16x32_bf16 v[36:39], v[56:59], v[188:191], v[36:39]
    s_nop 7
    v_permlane32_swap_b32 v36, v38
    v_permlane32_swap_b32 v37, v39
    s_nop 0
    v_add_f32_dpp v36, v38, v36 row_ror:8 row_mask:0xf bank_mask:0xf
    v_add_f32_dpp v37, v39, v37 row_ror:8 row_mask:0xf bank_mask:0xf
    v_mov_b32 v38, s42
    s_mov_b32 exec_lo, 0xff00ff
    s_mov_b32 exec_hi, 0xff00ff
    s_cmp_eq_u32 s44, 1
    s_cbranch_scc0 L_far22
    buffer_store_dwordx4 v[36:39], v19, s[16:19], s9 offen
    s_branch L_pb23
L_far22:
    buffer_store_dwordx4 v[36:39], v19, s[16:19], s9 offen sc1
L_pb23:
    s_mov_b64 exec, -1
    s_mov_b32 s68, 0
L_xe24:
    buffer_load_dwordx4 v[128:131], v12, s[16:19], s10 offen offset:0 sc1
    buffer_load_dwordx4 v[132:135], v12, s[16:19], s10 offen offset:1024 sc1
    s_add_u32 s68, s68, 1
    s_cmp_gt_u32 s68, 262144
    s_cbranch_scc1 L_END
    s_waitcnt vmcnt(0)
    v_xor_b32 v1, s42, v130
    v_xor_b32 v2, s42, v134
    v_or_b32 v1, v1, v2
    v_cmp_ne_u32 vcc, 0, v1
    s_cbranch_vccnz L_xe24
L_xex26:
    v_pk_add_f32 v[20:21], v[128:129], v[132:133]
L_xej25:
    s_nop 1
    v_add_f32_dpp v20, v20, v20 row_ror:8 row_mask:0xf bank_mask:0xf
    v_add_f32_dpp v21, v21, v21 row_ror:8 row_mask:0xf bank_mask:0xf
    v_cvt_pk_bf16_f32 v22, v20, v21
    v_lshlrev_b32 v20, 16, v22
    v_and_b32 v21, 0xffff0000, v22
    v_mov_b32_dpp v24, v22 row_shl:4 row_mask:0xf bank_mask:0xf
    v_mul_f32 v22, 0xbfb8aa3b, v20
    v_mul_f32 v23, 0xbfb8aa3b, v21
    v_exp_f32 v22, v22
    v_exp_f32 v23, v23
    v_add_f32 v22, 1.0, v22
    v_add_f32 v23, 1.0, v23
    v_rcp_f32 v22, v22
    v_rcp_f32 v23, v23
    v_mul_f32 v20, v20, v22
    v_mul_f32 v21, v21, v23
    v_lshlrev_b32 v26, 16, v24
    v_and_b32 v27, 0xffff0000, v24
    v_cvt_pk_bf16_f32 v22, v20, v21
    v_lshlrev_b32 v20, 16, v22
    v_and_b32 v21, 0xffff0000, v22
    v_mul_f32 v20, v20, v26
    v_mul_f32 v21, v21, v27
    v_cvt_pk_bf16_f32 v20, v20, v20
    v_cvt_pk_bf16_f32 v21, v21, v21
    s_nop 0
    v_and_b32_dpp v52, v20, v4 row_newbcast:0 row_mask:0xf bank_mask:0xf
    v_and_b32_dpp v53, v20, v5 row_newbcast:0 row_mask:0xf bank_mask:0xf
    v_and_b32_dpp v54, v20, v6 row_newbcast:0 row_mask:0xf bank_mask:0xf
    v_and_b32_dpp v55, v20, v7 row_newbcast:0 row_mask:0xf bank_mask:0xf
    v_and_b32_dpp v56, v21, v4 row_newbcast:0 row_mask:0xf bank_mask:0xf
    v_and_b32_dpp v57, v21, v5 row_newbcast:0 row_mask:0xf bank_mask:0xf
    v_and_b32_dpp v58, v21, v6 row_newbcast:0 row_mask:0xf bank_mask:0xf
    v_and_b32_dpp v59, v21, v7 row_newbcast:0 row_mask:0xf bank_mask:0xf
    v_mfma_f32_16x16x32_bf16 v[36:39], v[52:55], v[192:195], 0
    v_and_b32_dpp v52, v20, v4 row_newbcast:1 row_mask:0xf bank_mask:0xf
    v_and_b32_dpp v53, v20, v5 row_newbcast:1 row_mask:0xf bank_mask:0xf
    v_and_b32_dpp v54, v20, v6 row_newbcast:1 row_mask:0xf bank_mask:0xf
    v_and_b32_dpp v55, v20, v7 row_newbcast:1 row_mask:0xf bank_mask:0xf
    v_mfma_f32_16x16x32_bf16 v[36:39], v[56:59], v[196:199], v[36:39]
    v_and_b32_dpp v56, v21, v4 row_newbcast:1 row_mask:0xf bank_mask:0xf
    v_and_b32_dpp v57, v21, v5 row_newbcast:1 row_mask:0xf bank_mask:0xf
    v_and_b32_dpp v58, v21, v6 row_newbcast:1 row_mask:0xf bank_mask:0xf
    v_and_b32_dpp v59, v21, v7 row_newbcast:1 row_mask:0xf bank_mask:0xf
    v_mfma_f32_16x16x32_bf16 v[36:39], v[52:55], v[200:203], v[36:39]
    v_and_b32_dpp v52, v20, v4 row_newbcast:2 row_mask:0xf bank_mask:0xf
    v_and_b32_dpp v53, v20, v5 row_newbcast:2 row_mask:0xf bank_mask:0xf
    v_and_b32_dpp v54, v20, v6 row_newbcast:2 row_mask:0xf bank_mask:0xf
    v_and_b32_dpp v55, v20, v7 row_newbcast:2 row_mask:0xf bank_mask:0xf
    v_mfma_f32_16x16x32_bf16 v[36:39], v[56:59], v[204:207], v[36:39]
    v_and_b32_dpp v56, v21, v4 row_newbcast:2 row_mask:0xf bank_mask:0xf
    v_and_b32_dpp v57, v21, v5 row_newbcast:2 row_mask:0xf bank_mask:0xf
    v_and_b32_dpp v58, v21, v6 row_newbcast:2 row_mask:0xf bank_mask:0xf
    v_and_b32_dpp v59, v21, v7 row_newbcast:2 row_mask:0xf bank_mask:0xf
    v_mfma_f32_16x16x32_bf16 v[36:39], v[52:55], v[208:211], v[36:39]
    v_and_b32_dpp v52, v20, v4 row_newbcast:3 row_mask:0xf bank_mask:0xf
    v_and_b32_dpp v53, v20, v5 row_newbcast:3 row_mask:0xf bank_mask:0xf
    v_and_b32_dpp v54, v20, v6 row_newbcast:3 row_mask:0xf bank_mask:0xf
    v_and_b32_dpp v55, v20, v7 row_newbcast:3 row_mask:0xf bank_mask:0xf
    v_mfma_f32_16x16x32_bf16 v[36:39], v[56:59], v[212:215], v[36:39]
    v_and_b32_dpp v56, v21, v4 row_newbcast:3 row_mask:0xf bank_mask:0xf
    v_and_b32_dpp v57, v21, v5 row_newbcast:3 row_mask:0xf bank_mask:0xf
    v_and_b32_dpp v58, v21, v6 row_newbcast:3 row_mask:0xf bank_mask:0xf
    v_and_b32_dpp v59, v21, v7 row_newbcast:3 row_mask:0xf bank_mask:0xf
    v_mfma_f32_16x16x32_bf16 v[36:39], v[52:55], v[216:219], v[36:39]
    s_nop 0
    v_mfma_f32_16x16x32_bf16 v[36:39], v[56:59], v[220:223], v[36:39]
    s_nop 7
    v_permlane32_swap_b32 v36, v38
    v_permlane32_swap_b32 v37, v39
    v_mov_b32 v38, s42
    buffer_store_dwordx4 v[36:39], v17, s[16:19], s11 offen sc1
    s_branch L_END
L_C123:
    s_load_dword s42, s[40:41], 0
    s_mov_b32 s16, s40
    s_mov_b32 s17, s41
    s_mov_b32 s18, 0x300000
    s_mov_b32 s19, 0x20000
    v_and_b32 v1, 1, v0
    v_lshlrev_b32 v1, 4, v1
    v_mov_b32 v2, 0xffff
    v_lshlrev_b32 v2, v1, v2
    v_bfe_u32 v1, v0, 1, 2
    v_cmp_eq_u32 vcc, 0, v1
    s_nop 1
    v_cndmask_b32 v4, 0, v2, vcc
    v_cmp_eq_u32 vcc, 1, v1
    s_nop 1
    v_cndmask_b32 v5, 0, v2, vcc
    v_cmp_eq_u32 vcc, 2, v1
    s_nop 1
    v_cndmask_b32 v6, 0, v2, vcc
    v_cmp_eq_u32 vcc, 3, v1
    s_nop 1
    v_cndmask_b32 v7, 0, v2, vcc
    s_cmp_eq_u32 s3, 5
    s_cbranch_scc1 L_C1
L_C3:
    s_cmp_eq_u32 s3, 7
    s_cbranch_scc0 L_NOPM
    s_cmp_eq_u32 s2, 0
    s_cbranch_scc0 L_NOPM
    s_waitcnt lgkmcnt(0)
    s_mov_b32 s8, -1
    s_mov_b32 s9, -1
    s_mov_b32 s15, 0x190000
    s_memtime s[10:11]
    s_waitcnt lgkmcnt(0)
    s_load_dword s14, s[40:41], s15 glc
    s_waitcnt lgkmcnt(0)
    s_memtime s[12:13]
    s_waitcnt lgkmcnt(0)
    s_sub_u32 s12, s12, s10
    s_min_u32 s8, s8, s12
    s_mov_b32 s15, 0x192000
    s_memtime s[10:11]
    s_waitcnt lgkmcnt(0)
    s_load_dword s14, s[40:41], s15 glc
    s_waitcnt lgkmcnt(0)
    s_memtime s[12:13]
    s_waitcnt lgkmcnt(0)
    s_sub_u32 s12, s12, s10
    s_min_u32 s9, s9, s12
    s_mov_b32 s15, 0x190080
    s_memtime s[10:11]
    s_waitcnt lgkmcnt(0)
    s_load_dword s14, s[40:41], s15 glc
    s_waitcnt lgkmcnt(0)
    s_memtime s[12:13]
    s_waitcnt lgkmcnt(0)
    s_sub_u32 s12, s12, s10
    s_min_u32 s8, s8, s12
    s_mov_b32 s15, 0x192080
    s_memtime s[10:11]
    s_waitcnt lgkmcnt(0)
    s_load_dword s14, s[40:41], s15 glc
    s_waitcnt lgkmcnt(0)
    s_memtime s[12:13]
    s_waitcnt lgkmcnt(0)
    s_sub_u32 s12, s12, s10
    s_min_u32 s9, s9, s12
    s_mov_b32 s15, 0x190100
    s_memtime s[10:11]
    s_waitcnt lgkmcnt(0)
    s_load_dword s14, s[40:41], s15 glc
    s_waitcnt lgkmcnt(0)
    s_memtime s[12:13]
    s_waitcnt lgkmcnt(0)
    s_sub_u32 s12, s12, s10
    s_min_u32 s8, s8, s12
    s_mov_b32 s15, 0x192100
    s_memtime s[10:11]
    s_waitcnt lgkmcnt(0)
    s_load_dword s14, s[40:41], s15 glc
    s_waitcnt lgkmcnt(0)
    s_memtime s[12:13]
    s_waitcnt lgkmcnt(0)
    s_sub_u32 s12, s12, s10
    s_min_u32 s9, s9, s12
    s_mov_b32 s15, 0x190180
    s_memtime s[10:11]
    s_waitcnt lgkmcnt(0)
    s_load_dword s14, s[40:41], s15 glc
    s_waitcnt lgkmcnt(0)
    s_memtime s[12:13]
    s_waitcnt lgkmcnt(0)
    s_sub_u32 s12, s12, s10
    s_min_u32 s8, s8, s12
    s_mov_b32 s15, 0x192180
    s_memtime s[10:11]
    s_waitcnt lgkmcnt(0)
    s_load_dword s14, s[40:41], s15 glc
    s_waitcnt lgkmcnt(0)
    s_memtime s[12:13]
    s_waitcnt lgkmcnt(0)
    s_sub_u32 s12, s12, s10
    s_min_u32 s9, s9, s12
    s_cmp_lt_u32 s9, s8
    s_cselect_b32 s8, 1, 0
    s_getreg_b32 s9, hwreg(HW_REG_XCC_ID, 2, 1)
    s_xor_b32 s8, s8, s9
    s_add_u32 s9, s42, 1
    s_lshl_b32 s9, s9, 1
    s_or_b32 s8, s8, s9
    v_mov_b32 v2, s8
    v_lshlrev_b32 v1, 7, v0
    s_mov_b32 s8, 0x1f000
    s_mov_b32 exec_lo, 0xff
    s_mov_b32 exec_hi, 0x0
    buffer_store_dword v2, v1, s[16:19], s8 offen sc1
    s_mov_b64 exec, -1
L_NOPM:
    s_waitcnt lgkmcnt(0)
    s_add_u32 s42, s42, 1
    s_branch L_QKP
L_C23B1:
    s_barrier
    s_branch L_END
L_C1:
    s_waitcnt lgkmcnt(0)
    s_add_u32 s42, s42, 1
    s_mov_b32 s44, 0
    s_sub_u32 s45, s39, 8
    s_cmp_lt_u32 s45, 16
    s_cbranch_scc1 L_QKP
    v_mov_b32 v3, 0x21108
    s_mov_b32 s68, 0
L_k127:
    ds_read_b32 v28, v3
    s_add_u32 s68, s68, 1
    s_cmp_gt_u32 s68, 2097152
    s_cbranch_scc1 L_END
    s_waitcnt lgkmcnt(0)
    v_cmp_eq_u32 vcc, 0, v28
    s_cbranch_vccz L_k1d28
    s_sleep 8
    s_branch L_k127
L_k1d28:
    s_and_b32 s45, s39, 7
    s_lshr_b32 s46, s39, 4
    s_lshl_b32 s46, s46, 3
    s_add_u32 s45, s45, s46
    s_lshl_b32 s45, s45, 3
    s_add_u32 s45, s45, s38
    s_and_b32 s46, s45, 31
    s_lshr_b32 s45, s45, 5
    s_lshl_b32 s71, s46, 2
    s_add_u32 s71, s71, s45
    s_lshl_b32 s71, s71, 9
    s_add_u32 s71, s71, 0x9000
    s_lshl_b32 s46, s46, 7
    s_add_u32 s46, s46, 2048
    s_mov_b32 s20, s60
    s_mov_b32 s21, s61
    s_mov_b32 s22, 0x400
    s_mov_b32 s23, 0x20000
    s_mov_b32 s24, s62
    s_mov_b32 s25, s63
    s_mov_b32 s26, 0x300000
    s_mov_b32 s27, 0x20000
    s_lshl_b32 s70, s45, 8
    buffer_load_dword v18, v16, s[20:23], s70 offen
    s_mul_i32 s70, s45, 786432
    s_add_u32 s70, s70, s46
    buffer_load_dwordx4 v[64:67], v17, s[24:27], s70 offen nt
    s_add_u32 s70, s70, 6144
    buffer_load_dwordx4 v[68:71], v17, s[24:27], s70 offen nt
    s_add_u32 s70, s70, 6144
    buffer_load_dwordx4 v[72:75], v17, s[24:27], s70 offen nt
    s_add_u32 s70, s70, 6144
    buffer_load_dwordx4 v[76:79], v17, s[24:27], s70 offen nt
    s_add_u32 s70, s70, 6144
    buffer_load_dwordx4 v[80:83], v17, s[24:27], s70 offen nt
    s_add_u32 s70, s70, 6144
    buffer_load_dwordx4 v[84:87], v17, s[24:27], s70 offen nt
    s_add_u32 s70, s70, 6144
    buffer_load_dwordx4 v[88:91], v17, s[24:27], s70 offen nt
    s_add_u32 s70, s70, 6144
    buffer_load_dwordx4 v[92:95], v17, s[24:27], s70 offen nt
    s_add_u32 s70, s70, 6144
    buffer_load_dwordx4 v[96:99], v17, s[24:27], s70 offen nt
    s_add_u32 s70, s70, 6144
    buffer_load_dwordx4 v[100:103], v17, s[24:27], s70 offen nt
    s_add_u32 s70, s70, 6144
    buffer_load_dwordx4 v[104:107], v17, s[24:27], s70 offen nt
    s_add_u32 s70, s70, 6144
    buffer_load_dwordx4 v[108:111], v17, s[24:27], s70 offen nt
    s_add_u32 s70, s70, 6144
    buffer_load_dwordx4 v[112:115], v17, s[24:27], s70 offen nt
    s_add_u32 s70, s70, 6144
    buffer_load_dwordx4 v[116:119], v17, s[24:27], s70 offen nt
    s_add_u32 s70, s70, 6144
    buffer_load_dwordx4 v[120:123], v17, s[24:27], s70 offen nt
    s_add_u32 s70, s70, 6144
    buffer_load_dwordx4 v[124:127], v17, s[24:27], s70 offen nt
    s_mov_b32 s44, 99
    s_branch L_QKP
L_C1B1:
    s_sub_u32 s45, s39, 8
    s_cmp_lt_u32 s45, 8
    s_cbranch_scc1 L_RED
    s_barrier
    s_branch L_END
L_RED:
    s_mov_b32 s24, s66
    s_mov_b32 s25, s67
    s_mov_b32 s26, 0x400
    s_mov_b32 s27, 0x20000
    v_lshlrev_b32 v16, 4, v0
    v_and_b32 v15, 3, v0
    v_lshlrev_b32 v15, 4, v15
    v_lshrrev_b32 v1, 4, v0
    v_lshl_add_u32 v17, v1, 14, v15
    v_bfe_u32 v1, v0, 2, 2
    v_lshl_add_u32 v17, v1, 11, v17
    v_mov_b32 v19, 0x211b0
    ds_read_b32 v19, v19
    s_waitcnt lgkmcnt(0)
    v_readfirstlane_b32 s52, v19
    s_nop 0
    s_and_b32 s52, s52, 1
    s_lshr_b32 s53, s38, 2
    s_xor_b32 s53, s53, s52
    s_lshl_b32 s53, s53, 13
    s_lshl_b32 s69, s76, 15
    s_add_u32 s69, s69, s53
    s_add_u32 s69, s69, 0x140000
    s_add_u32 s12, s69, 0
    s_add_u32 s13, s69, 4096
    s_add_u32 s14, s69, 16384
    s_add_u32 s15, s69, 20480
    s_lshr_b32 s72, s38, 1
    s_lshl_b32 s72, s72, 14
    s_and_b32 s45, s38, 1
    s_lshl_b32 s45, s45, 12
    s_add_u32 s72, s72, s45
    s_add_u32 s72, s72, 0x180000
    s_lshl_b32 s46, s76, 9
    s_add_u32 s72, s72, s46
    s_add_u32 s72, s72, s53
    s_lshr_b32 s71, s76, 1
    s_lshl_b32 s71, s71, 9
    s_and_b32 s46, s76, 1
    s_lshl_b32 s46, s46, 7
    s_add_u32 s71, s71, s46
    s_and_b32 s46, s38, 1
    s_lshl_b32 s46, s46, 6
    s_add_u32 s71, s71, s46
    s_and_b32 s46, s38, 2
    s_lshl_b32 s46, s46, 7
    s_add_u32 s71, s71, s46
    s_add_u32 s71, s71, s53
    s_add_u32 s71, s71, 0xe0000
    s_add_u32 s8, s71, 0x0
    s_add_u32 s9, s71, 0x10000
    s_add_u32 s10, s71, 0x20000
    s_barrier
    v_mov_b32 v3, 0x211a0
    s_mov_b32 s68, 0
L_rw29:
    ds_read_b32 v28, v3
    s_add_u32 s68, s68, 1
    s_cmp_gt_u32 s68, 2097152
    s_cbranch_scc1 L_END
    s_waitcnt lgkmcnt(0)
    v_cmp_eq_u32 vcc, 0, v28
    s_cbranch_vccz L_rwd30
    s_sleep 1
    s_branch L_rw29
L_rwd30:
    s_mov_b32 s68, 0
L_x431:
    buffer_load_dwordx4 v[64:67], v16, s[16:19], s4 offen offset:0 sc1
    buffer_load_dwordx4 v[68:71], v16, s[16:19], s4 offen offset:1024 sc1
    buffer_load_dwordx4 v[72:75], v16, s[16:19], s5 offen offset:0 sc1
    buffer_load_dwordx4 v[76:79], v16, s[16:19], s5 offen offset:1024 sc1
    buffer_load_dwordx4 v[80:83], v16, s[16:19], s6 offen offset:0 sc1
    buffer_load_dwordx4 v[84:87], v16, s[16:19], s6 offen offset:1024 sc1
    buffer_load_dwordx4 v[88:91], v16, s[16:19], s7 offen offset:0 sc1
    buffer_load_dwordx4 v[92:95], v16, s[16:19], s7 offen offset:1024 sc1
    s_add_u32 s68, s68, 1
    s_cmp_gt_u32 s68, 262144
    s_cbranch_scc1 L_END
    s_waitcnt vmcnt(0)
    v_xor_b32 v1, s42, v66
    v_xor_b32 v2, s42, v70
    v_bitop3_b32 v1, v74, s42, v1 bitop3:0xbe
    v_bitop3_b32 v2, v78, s42, v2 bitop3:0xbe
    v_bitop3_b32 v1, v82, s42, v1 bitop3:0xbe
    v_bitop3_b32 v2, v86, s42, v2 bitop3:0xbe
    v_bitop3_b32 v1, v90, s42, v1 bitop3:0xbe
    v_bitop3_b32 v2, v94, s42, v2 bitop3:0xbe
    v_or_b32 v1, v1, v2
    v_cmp_ne_u32 vcc, 0, v1
    s_cbranch_vccnz L_x431
    v_add_f32 v64, v64, v68
    v_add_f32 v65, v65, v69
    v_add_f32 v72, v72, v76
    v_add_f32 v73, v73, v77
    v_add_f32 v80, v80, v84
    v_add_f32 v81, v81, v85
    v_add_f32 v88, v88, v92
    v_add_f32 v89, v89, v93
    v_permlane32_swap_b32 v64, v65
    v_permlane32_swap_b32 v72, v73
    v_permlane32_swap_b32 v80, v81
    v_permlane32_swap_b32 v88, v89
    v_add_f32 v64, v64, v65
    v_add_f32 v72, v72, v73
    v_add_f32 v80, v80, v81
    v_add_f32 v88, v88, v89
    v_cvt_pk_bf16_f32 v64, v64, v64
    v_and_b32 v64, 0xffff0000, v64
    v_cvt_pk_bf16_f32 v72, v72, v72
    v_and_b32 v72, 0xffff0000, v72
    v_cvt_pk_bf16_f32 v80, v80, v80
    v_and_b32 v80, 0xffff0000, v80
    v_cvt_pk_bf16_f32 v88, v88, v88
    v_and_b32 v88, 0xffff0000, v88
    v_mov_b32 v13, v64
    v_add_f32 v80, 1.0, v80
    v_mov_b32 v73, v72
    v_mov_b32 v81, v80
    ds_bpermute_b32 v14, v18, v88
    v_permlane32_swap_b32 v72, v73
    v_permlane32_swap_b32 v80, v81
    v_cvt_pk_bf16_f32 v22, v72, v73
    v_cvt_pk_bf16_f32 v21, v80, v81
    v_mov_b32 v23, s42
    v_lshlrev_b32 v12, 16, v12
    s_mov_b32 s68, 0
L_xb32:
    buffer_load_dwordx4 v[128:131], v16, s[16:19], s12 offen offset:0 sc1
    buffer_load_dwordx4 v[132:135], v16, s[16:19], s12 offen offset:1024 sc1
    buffer_load_dwordx4 v[136:139], v16, s[16:19], s12 offen offset:2048 sc1
    buffer_load_dwordx4 v[140:143], v16, s[16:19], s12 offen offset:3072 sc1
    buffer_load_dwordx4 v[144:147], v16, s[16:19], s13 offen offset:0 sc1
    buffer_load_dwordx4 v[148:151], v16, s[16:19], s13 offen offset:1024 sc1
    buffer_load_dwordx4 v[152:155], v16, s[16:19], s13 offen offset:2048 sc1
    buffer_load_dwordx4 v[156:159], v16, s[16:19], s13 offen offset:3072 sc1
    buffer_load_dwordx4 v[160:163], v16, s[16:19], s14 offen offset:0 sc1
    buffer_load_dwordx4 v[164:167], v16, s[16:19], s14 offen offset:1024 sc1
    buffer_load_dwordx4 v[168:171], v16, s[16:19], s14 offen offset:2048 sc1
    buffer_load_dwordx4 v[172:175], v16, s[16:19], s14 offen offset:3072 sc1
    buffer_load_dwordx4 v[176:179], v16, s[16:19], s15 offen offset:0 sc1
    buffer_load_dwordx4 v[180:183], v16, s[16:19], s15 offen offset:1024 sc1
    buffer_load_dwordx4 v[184:187], v16, s[16:19], s15 offen offset:2048 sc1
    buffer_load_dwordx4 v[188:191], v16, s[16:19], s15 offen offset:3072 sc1
    s_add_u32 s68, s68, 1
    s_cmp_gt_u32 s68, 262144
    s_cbranch_scc1 L_END
    s_waitcnt vmcnt(0)
    v_xor_b32 v1, s42, v130
    v_xor_b32 v2, s42, v134
    v_bitop3_b32 v1, v138, s42, v1 bitop3:0xbe
    v_bitop3_b32 v2, v142, s42, v2 bitop3:0xbe
    v_bitop3_b32 v1, v146, s42, v1 bitop3:0xbe
    v_bitop3_b32 v2, v150, s42, v2 bitop3:0xbe
    v_bitop3_b32 v1, v154, s42, v1 bitop3:0xbe
    v_bitop3_b32 v2, v158, s42, v2 bitop3:0xbe
    v_bitop3_b32 v1, v162, s42, v1 bitop3:0xbe
    v_bitop3_b32 v2, v166, s42, v2 bitop3:0xbe
    v_bitop3_b32 v1, v170, s42, v1 bitop3:0xbe
    v_bitop3_b32 v2, v174, s42, v2 bitop3:0xbe
    v_bitop3_b32 v1, v178, s42, v1 bitop3:0xbe
    v_bitop3_b32 v2, v182, s42, v2 bitop3:0xbe
    v_bitop3_b32 v1, v186, s42, v1 bitop3:0xbe
    v_bitop3_b32 v2, v190, s42, v2 bitop3:0xbe
    v_or_b32 v1, v1, v2
    v_cmp_ne_u32 vcc, 0, v1
    s_cbranch_vccnz L_xb32
L_xbx34:
    v_pk_add_f32 v[128:129], v[128:129], v[132:133]
    v_pk_add_f32 v[136:137], v[136:137], v[140:141]
    v_pk_add_f32 v[144:145], v[144:145], v[148:149]
    v_pk_add_f32 v[152:153], v[152:153], v[156:157]
    v_pk_add_f32 v[160:161], v[160:161], v[164:165]
    v_pk_add_f32 v[168:169], v[168:169], v[172:173]
    v_pk_add_f32 v[176:177], v[176:177], v[180:181]
    v_pk_add_f32 v[184:185], v[184:185], v[188:189]
    v_pk_add_f32 v[128:129], v[128:129], v[136:137]
    v_pk_add_f32 v[144:145], v[144:145], v[152:153]
    v_pk_add_f32 v[160:161], v[160:161], v[168:169]
    v_pk_add_f32 v[176:177], v[176:177], v[184:185]
    v_pk_add_f32 v[128:129], v[128:129], v[144:145]
    v_pk_add_f32 v[160:161], v[160:161], v[176:177]
    v_pk_add_f32 v[128:129], v[128:129], v[160:161]
L_xbj33:
    s_nop 1
    v_permlane32_swap_b32 v128, v129
    v_add_f32 v64, v128, v129
    v_cvt_pk_bf16_f32 v64, v64, v64
    v_and_b32 v64, 0xffff0000, v64
    v_mul_f32 v64, v64, v13
    v_cvt_pk_bf16_f32 v64, v64, v64
    v_and_b32 v64, 0xffff0000, v64
    v_add_f32 v64, v64, v12
    v_mov_b32 v65, v64
    s_nop 1
    v_permlane32_swap_b32 v64, v65
    v_cvt_pk_bf16_f32 v20, v64, v65
    s_mov_b32 exec_lo, 0xffffffff
    s_mov_b32 exec_hi, 0x0
    s_cmp_eq_u32 s73, 1
    s_cbranch_scc0 L_far35
    buffer_store_dwordx4 v[20:23], v16, s[16:19], s72 offen
    s_branch L_pb36
L_far35:
    buffer_store_dwordx4 v[20:23], v16, s[16:19], s72 offen sc1
L_pb36:
    s_mov_b64 exec, -1
    s_cmp_eq_u32 s44, 0
    s_cbranch_scc0 L_NOEP
    s_mov_b64 exec, 1
    v_mov_b32 v1, 0
    v_mov_b32 v2, s42
    buffer_store_dword v2, v1, s[16:19], 0 offen sc1
    s_mov_b64 exec, -1
L_NOEP:
    v_lshrrev_b32 v3, 1, v0
    v_and_b32 v3, 16, v3
    v_lshrrev_b32 v12, v3, v20
    v_lshlrev_b32 v12, 16, v12
    ds_bpermute_b32 v12, v18, v12
    s_waitcnt lgkmcnt(0)
    s_mov_b32 s68, 0
L_xd37:
    buffer_load_dwordx4 v[192:195], v17, s[16:19], s8 offen sc1
    buffer_load_dwordx4 v[196:199], v17, s[16:19], s9 offen sc1
    s_mov_b32 exec_lo, 0xffffffff
    s_mov_b32 exec_hi, 0xfff
    buffer_load_dwordx4 v[200:203], v17, s[16:19], s10 offen sc1
    s_mov_b64 exec, -1
    s_add_u32 s68, s68, 1
    s_cmp_gt_u32 s68, 262144
    s_cbranch_scc1 L_END
    s_waitcnt vmcnt(0)
    v_xor_b32 v1, s42, v194
    v_xor_b32 v2, s42, v198
    v_bitop3_b32 v1, v202, s42, v1 bitop3:0xbe
    v_or_b32 v1, v1, v2
    v_cmp_ne_u32 vcc, 0, v1
    s_cbranch_vccnz L_xd37
L_xdx39:
    v_pk_add_f32 v[192:193], v[192:193], v[196:197]
    v_pk_add_f32 v[64:65], v[192:193], v[200:201]
L_xdj38:
    s_nop 1
    v_permlane16_swap_b32 v64, v65
    v_add_f32 v64, v64, v65
    s_nop 1
    v_add_f32_dpp v64, v64, v64 row_ror:4 row_mask:0xf bank_mask:0xf
    s_nop 1
    v_add_f32_dpp v64, v64, v64 row_ror:8 row_mask:0xf bank_mask:0xf
    v_mov_b32 v65, v64
    s_nop 1
    v_permlane32_swap_b32 v64, v65
    v_add_f32 v64, v64, v65
    v_cvt_pk_bf16_f32 v64, v64, v64
    v_and_b32 v64, 0xffff0000, v64
    v_mul_f32 v64, v64, v14
    v_cvt_pk_bf16_f32 v64, v64, v64
    v_and_b32 v64, 0xffff0000, v64
    v_add_f32 v64, v64, v12
    v_mov_b32 v65, v64
    s_nop 1
    v_permlane16_swap_b32 v64, v65
    v_cvt_pk_bf16_f32 v64, v64, v65
    s_mov_b64 exec, 15
    buffer_store_dword v64, v15, s[24:27], s78 offen
    s_branch L_END
L_END:
    s_endpgm
L_CODE_END:
.section .rodata,"a"
.p2align 6
.amdhsa_kernel adaLN_cond__mha_block_cached__glu_gated_swiglu__decode_kernel
  .amdhsa_next_free_vgpr 256
  .amdhsa_next_free_sgpr 102
  .amdhsa_accum_offset 256
  .amdhsa_group_segment_fixed_size 0
  .amdhsa_kernarg_size 112
  .amdhsa_user_sgpr_count 2
  .amdhsa_user_sgpr_kernarg_segment_ptr 1
  .amdhsa_system_sgpr_workgroup_id_x 1
  .amdhsa_float_denorm_mode_32 3
.end_amdhsa_kernel
```
